```python
import torch

def _softmax(x, axis=-1):
    return torch.softmax(x, dim=axis)
def _gelu(x):
    return torch.nn.functional.gelu(x, approximate="tanh")
def _silu(x):
    return torch.nn.functional.silu(x)
def _sigmoid(x):
    return torch.sigmoid(x)
def _layernorm(x, axis=-1, eps=1e-5):
    m = x.mean(dim=axis, keepdim=True)
    v = x.var(dim=axis, keepdim=True, unbiased=False)
    return (x - m) / torch.sqrt(v + eps)
def _scatter_add(tgt, idx, src, axis=0):
    return tgt.clone().index_add_(axis, idx, src)
def _segment_sum(src, seg, n):
    out = torch.zeros((n,) + src.shape[1:], dtype=src.dtype)
    return out.index_add_(0, seg, src)
def _pad(x, pw):
    flat = tuple(v for pair in reversed(pw) for v in pair)
    return torch.nn.functional.pad(x, flat)

kernel_name = 'gated_mix__sliding_local_dilated__dense_activation_mish__prompt'

def setup_inputs():

    _w = (lambda a: (lambda t: t.to(torch.bfloat16) if t.is_floating_point() else t)(torch.as_tensor(a)))
    def _A_setup():
        B, S, D = 1, 2048, 512
        return {
            "x": _w((lambda *s: torch.randn(*s, dtype=torch.bfloat16) * 0.05)(B, S, D)),
            "wqkv": _w((lambda *s: torch.randn(*s, dtype=torch.bfloat16) * 0.8)(D, 3 * D)),
            "wo": _w((lambda *s: torch.randn(*s, dtype=torch.bfloat16) * 0.05)(D, D)),
        }
    _A_in = _A_setup()

    def _B_setup():
        B, S, D, F = 1, 2048, 512, 1376
        return {
            "x": _w((lambda *s: torch.randn(*s, dtype=torch.bfloat16) * 0.05)(B, S, D)),
            "w1": _w((lambda *s: torch.randn(*s, dtype=torch.bfloat16) * 12.8)(D, F) * (D ** -0.5)),
            "b1": _w((lambda *s: torch.randn(*s, dtype=torch.bfloat16) * 0.8)(F)),
            "w2": _w((lambda *s: torch.randn(*s, dtype=torch.bfloat16) * 0.8)(F, D) * (F ** -0.5)),
        }
    _B_in = _B_setup()

    return {
        "A_x": _A_in["x"],
        "A_wqkv": _A_in["wqkv"],
        "A_wo": _A_in["wo"],
        "B_x": _B_in["x"],
        "B_w1": _B_in["w1"],
        "B_b1": _B_in["b1"],
        "B_w2": _B_in["w2"],
        "gate_w": _w((lambda *s: torch.randn(*s, dtype=torch.bfloat16) * 0.05)(512) * 16.0),
    }

def reference(A_x, A_wqkv, A_wo, B_x, B_w1, B_b1, B_w2, gate_w):
    def _A_ref(x, wqkv, wo):
        B, S, D = x.shape
        H = 32; Dh = D // H
        W, dil = 8, 2
        qkv = (lambda x, *d: x.permute(*d))((x @ wqkv).reshape(B, S, 3, H, Dh), 2, 0, 3, 1, 4)
        q, k, v = qkv[0], qkv[1], qkv[2]
        scale = Dh ** -0.5
        pos = torch.arange(S)
        off = torch.arange(W) * dil
        idx = pos[:, None] - off[None, :]
        mask = idx >= 0
        idx_c = torch.where(mask, idx, 0).reshape(-1)
        kg = k[:, :, idx_c, :].reshape(B, H, S, W, Dh)
        vg = v[:, :, idx_c, :].reshape(B, H, S, W, Dh)
        logits = torch.einsum("bhsd,bhswd->bhsw", q, kg) * scale
        logits = torch.where(mask[None, None, :, :], logits, -1e9)
        attn = _softmax(logits, axis=-1)
        o = torch.einsum("bhsw,bhswd->bhsd", attn, vg)
        return (lambda x, *d: x.permute(*d))(o, 0, 2, 1, 3).reshape(B, S, D) @ wo

    def _B_ref(x, w1, b1, w2):
        h = torch.einsum("bsd,df->bsf", x, w1) + b1
        sp = torch.log1p(torch.exp(-torch.abs(h))) + torch.where(h > 0, h, torch.zeros_like(h))
        act = h * torch.tanh(sp)
        return torch.einsum("bsf,fd->bsd", act, w2)

    x = A_x
    g = _sigmoid((x * gate_w).sum(-1, keepdims=True))
    a = _A_ref(x, A_wqkv, A_wo)
    b = _B_ref(x, B_w1, B_b1, B_w2)
    return g * a + (1 - g) * b
```

```asm
; @launch grid=(256,1,1) block=(256,1,1) lds=163840
.amdgcn_target "amdgcn-amd-amdhsa--gfx950"
.text
  .globl gated_mix__sliding_local_dilated__dense_activation_mish__prompt_kernel
  .p2align 8
  .type gated_mix__sliding_local_dilated__dense_activation_mish__prompt_kernel,@function
gated_mix__sliding_local_dilated__dense_activation_mish__prompt_kernel:
  s_cmp_ge_u32 s2, 256
  s_cbranch_scc1 Lend
  s_load_dwordx4 s[4:7], s[0:1], 0
  s_load_dwordx4 s[12:15], s[0:1], 32
  s_load_dwordx4 s[44:47], s[0:1], 48
  s_load_dwordx2 s[8:9], s[0:1], 16
  s_load_dwordx4 s[48:51], s[0:1], 64
  s_load_dwordx2 s[10:11], s[0:1], 80
  v_lshrrev_b32 v4, 6, v0
  v_and_b32 v1, 63, v0
  v_lshrrev_b32 v2, 4, v1
  v_and_b32 v3, 15, v1
  v_readfirstlane_b32 s40, v4
  s_getpc_b64 s[16:17]
Lpc:
  s_lshr_b32 s18, s2, 3
  s_mul_i32 s18, s18, 10
  v_min_u32 v5, 9, v1
  v_add_u32 v5, s18, v5
  v_lshlrev_b32 v5, 7, v5
  v_min_u32 v5, (Lend-Lpc), v5
  s_cmp_eq_u32 s40, 0
  s_cbranch_scc0 Lnopf
  global_load_dword v255, v5, s[16:17]
Lnopf:
  s_and_b32 s67, s2, 4
  s_lshl_b32 s41, s67, 1
  s_lshr_b32 s69, s2, 5
  s_add_u32 s41, s41, s69
  s_and_b32 s68, s2, 3
  s_lshl_b32 s68, s68, 1
  s_bfe_u32 s70, s2, 0x10003
  s_add_u32 s43, s68, s70
  s_bfe_u32 s42, s2, 0x10004
  s_and_b32 s69, s69, 3
  s_add_u32 s69, s69, s67
  s_add_u32 s69, s69, s43
  s_and_b32 s71, s69, 7
  s_lshr_b32 s52, s40, 1
  s_and_b32 s53, s40, 1
  s_lshl_b32 s59, s71, 7
  s_lshl_b32 s56, s40, 12
  s_add_u32 s57, s40, 16
  s_lshl_b32 s57, s57, 10
  s_mul_i32 s58, s40, 6144
  s_add_u32 s58, s58, 18432
  s_mov_b32 s54, 0
  s_mov_b32 s63, 43008
  s_mov_b32 s55, 86016
  v_lshrrev_b32 v4, 3, v1
  v_and_b32 v5, 7, v1
  v_xor_b32 v6, v5, v2
  v_lshlrev_b32 v7, 10, v4
  v_lshl_add_u32 v8, v6, 4, v7
  v_xor_b32 v9, 64, v8
  s_mul_i32 s64, s43, 6
  s_mul_i32 s65, s43, 5
  s_add_u32 s65, s65, 3
  s_cmp_le_u32 s43, 3
  s_cselect_b32 s64, s64, s65
  s_lshl_b32 s70, s41, 17
  s_cmp_eq_u32 s42, 0
  s_cselect_b32 s65, 16384, 0
  s_cselect_b32 s3, 1, 0
  s_sub_u32 s70, s70, s65
  s_cmp_lt_u32 s40, 2
  s_cselect_b32 s3, s3, 0
  s_lshl_b32 s65, s40, 15
  s_add_u32 s65, s65, s70
  s_cmp_lt_i32 s65, 0
  s_cselect_b32 s66, 16384, 0
  s_add_u32 s66, s66, s65
  v_add_u32 v16, s66, v8
  s_add_u32 s67, s66, 8192
  v_add_u32 v17, s67, v9
  s_add_u32 s67, s65, 16384
  v_add_u32 v18, s67, v8
  s_add_u32 s67, s65, 24576
  v_add_u32 v19, s67, v9
  s_lshl_b32 s65, s40, 13
  s_add_u32 s65, s65, s70
  s_add_u32 s65, s65, 131072
  s_lshl_b32 s66, s53, 6
  v_xor_b32 v10, s66, v8
  v_add_u32 v20, s65, v10
  s_waitcnt lgkmcnt(0)
  s_mov_b32 s16, s4
  s_and_b32 s17, s5, 0xffff
  s_mov_b32 s18, 2097152
  s_mov_b32 s19, 0x00020000
  s_add_u32 m0, s54, s57
  s_nop 0
  s_cmp_eq_u32 s3, 1
  s_cbranch_scc0 1f
  buffer_load_dwordx4 v20, s[16:19], s59 offen lds
1:
  s_add_u32 m0, s54, s56
  s_nop 0
  buffer_load_dwordx4 v16, s[16:19], s59 offen lds
  s_add_u32 m0, m0, 1024
  s_nop 0
  buffer_load_dwordx4 v17, s[16:19], s59 offen lds
  s_add_u32 m0, m0, 1024
  s_nop 0
  buffer_load_dwordx4 v18, s[16:19], s59 offen lds
  s_add_u32 m0, m0, 1024
  s_nop 0
  buffer_load_dwordx4 v19, s[16:19], s59 offen lds
  s_add_u32 s59, s59, 128
  s_and_b32 s59, s59, 1023
  s_lshl_b32 s65, s43, 7
  s_lshl_b32 s66, s64, 6
  s_cmp_eq_u32 s42, 0
  s_cselect_b32 s69, s65, s66
  s_movk_i32 s65, 2752
  s_cselect_b32 s67, 3072, s65
  s_movk_i32 s65, 128
  s_cselect_b32 s68, 1024, s65
  s_cselect_b32 s20, s6, s12
  s_cselect_b32 s21, s7, s13
  s_and_b32 s21, s21, 0xffff
  s_lshl_b32 s22, s67, 9
  s_mov_b32 s23, 0x00020000
  s_lshl_b32 s62, s67, 6
  s_mul_i32 s60, s71, s62
  v_mul_lo_u32 v7, s67, v4
  v_and_b32 v8, 1, v2
  v_lshlrev_b32 v8, 1, v8
  v_xor_b32 v8, v8, v5
  v_xor_b32 v9, 4, v8
  v_lshl_add_u32 v10, v8, 4, v7
  v_lshl_add_u32 v11, v9, 4, v7
  s_mul_i32 s65, s40, 6
  s_lshr_b32 s66, s65, 3
  s_and_b32 s65, s65, 7
  s_mul_i32 s66, s66, s68
  s_lshl_b32 s70, s67, 3
  s_mul_i32 s65, s65, s70
  s_add_u32 s65, s65, s66
  s_add_u32 s65, s65, s69
  s_mul_i32 s66, s67, 56
  s_sub_u32 s69, s68, s66
  s_cmp_eq_u32 s40, 1
  s_cselect_b32 s67, s69, s70
  s_cmp_eq_u32 s40, 2
  s_cselect_b32 s68, s69, s70
  v_add_u32 v21, s65, v10
  s_add_u32 s65, s65, s70
  v_add_u32 v22, s65, v11
  s_add_u32 s65, s65, s67
  v_add_u32 v23, s65, v10
  s_add_u32 s65, s65, s70
  v_add_u32 v24, s65, v11
  s_add_u32 s65, s65, s68
  v_add_u32 v25, s65, v10
  s_add_u32 s65, s65, s70
  v_add_u32 v26, s65, v11
  s_cmp_ge_u32 s43, 3
  s_cselect_b32 s65, s52, 0
  s_and_b32 s65, s65, s42
  s_cmp_eq_u32 s65, 1
  s_cbranch_scc0 Lwoffdone
  v_lshrrev_b32 v12, 2, v8
  v_lshlrev_b32 v12, 30, v12
  v_xor_b32 v13, 0x40000000, v12
  v_add_u32 v25, v25, v12
  v_add_u32 v26, v26, v13
  s_cmp_eq_u32 s40, 3
  s_cbranch_scc0 Lwoffdone
  v_add_u32 v21, v21, v12
  v_add_u32 v22, v22, v13
  v_add_u32 v23, v23, v12
  v_add_u32 v24, v24, v13
Lwoffdone:
  s_add_u32 m0, s54, s58
  s_nop 0
  buffer_load_dwordx4 v21, s[20:23], s60 offen lds
  s_add_u32 m0, m0, 1024
  s_nop 0
  buffer_load_dwordx4 v22, s[20:23], s60 offen lds
  s_add_u32 m0, m0, 1024
  s_nop 0
  buffer_load_dwordx4 v23, s[20:23], s60 offen lds
  s_add_u32 m0, m0, 1024
  s_nop 0
  buffer_load_dwordx4 v24, s[20:23], s60 offen lds
  s_add_u32 m0, m0, 1024
  s_nop 0
  buffer_load_dwordx4 v25, s[20:23], s60 offen lds
  s_add_u32 m0, m0, 1024
  s_nop 0
  buffer_load_dwordx4 v26, s[20:23], s60 offen lds
  s_add_u32 s60, s60, s62
  s_cmp_eq_u32 s60, s22
  s_cselect_b32 s60, 0, s60
  s_cmp_eq_u32 s42, 0
  s_cbranch_scc0 Lffn
  s_add_u32 s67, s43, 0
  s_lshl_b32 s67, s67, 3
  s_lshl_b32 s66, s41, 7
  s_add_u32 s67, s67, s66
  s_lshl_b32 s66, s40, 1
  s_add_u32 s65, s67, s66
  s_lshl_b32 s66, s65, 10
  s_lshl_b32 s65, s65, 2
  v_lshlrev_b32 v5, 4, v1
  v_add_u32 v4, s66, v5
  v_mov_b32 v86, s65
  s_add_u32 s67, s67, 16384
  s_lshl_b32 s66, s41, 4
  v_cmp_eq_u32 s[28:29], 0, v0
  v_mov_b32 v7, 0x40000000
  v_mov_b32 v8, s67
  v_mov_b32 v95, s66
  v_cndmask_b32 v94, v7, v8, s[28:29]
  s_add_u32 s36, s10, 8388608
  s_addc_u32 s37, s11, 0
  s_and_b32 s37, s37, 0xffff
  s_mov_b32 s38, 32768
  s_mov_b32 s39, 0x00020000
  v_mov_b32 v7, 0
  buffer_store_dword v7, v94, s[36:39], 0 offen sc1
  s_cmp_eq_u32 s40, 0
  s_cselect_b64 s[4:5], 1, 0
  s_mov_b32 s28, s46
  s_and_b32 s29, s47, 0xffff
  s_mov_b32 s30, 1024
  s_mov_b32 s31, 0x00020000
  buffer_load_dwordx4 v[44:47], v4, s[16:19], 0 offen
  buffer_load_dwordx4 v[48:51], v4, s[16:19], 0 offen offset:1024
  buffer_load_dwordx4 v[52:55], v5, s[28:31], 0 offen
  v_lshrrev_b32 v7, 1, v3
  s_lshl_b32 s65, s52, 13
  v_or_b32 v8, 0, v2
  v_xor_b32 v8, v8, v7
  v_lshlrev_b32 v8, 4, v8
  v_lshl_add_u32 v8, v3, 7, v8
  v_add_u32 v27, s65, v8
  v_or_b32 v8, 4, v2
  v_xor_b32 v8, v8, v7
  v_lshlrev_b32 v8, 4, v8
  v_lshl_add_u32 v8, v3, 7, v8
  v_add_u32 v28, s65, v8
  v_bfe_u32 v7, v1, 2, 2
  v_and_b32 v8, 3, v1
  v_lshl_add_u32 v9, v2, 3, v7
  v_lshlrev_b32 v9, 7, v9
  v_and_b32 v10, 1, v8
  v_lshl_add_u32 v9, v10, 3, v9
  v_and_b32 v10, 2, v7
  v_and_b32 v11, 1, v2
  v_lshl_or_b32 v10, v11, 2, v10
  s_add_u32 m0, s63, s57
  s_nop 0
  s_cmp_eq_u32 s3, 1
  s_cbranch_scc0 1f
  buffer_load_dwordx4 v20, s[16:19], s59 offen lds
1:
  v_lshrrev_b32 v11, 1, v8
  v_xor_b32 v10, v10, v11
  s_lshl_b32 s65, s53, 2
  s_add_u32 s65, s65, 0
  v_xor_b32 v11, s65, v10
  v_lshl_add_u32 v11, v11, 4, v9
  v_add_u32 v29, 18432, v11
  s_lshl_b32 s65, s53, 2
  s_add_u32 s65, s65, 2
  v_xor_b32 v11, s65, v10
  v_lshl_add_u32 v11, v11, 4, v9
  v_add_u32 v30, 18432, v11
  s_mov_b32 s32, s10
  s_and_b32 s33, s11, 0xffff
  s_mov_b32 s34, 7733248
  s_mov_b32 s35, 0x00020000
  s_and_b32 s65, s2, 7
  s_lshr_b32 s66, s2, 3
  s_lshr_b32 s12, s65, 1
  s_lshl_b32 s12, s12, 3
  s_lshr_b32 s67, s66, 2
  s_add_u32 m0, s63, s56
  s_nop 0
  buffer_load_dwordx4 v16, s[16:19], s59 offen lds
  s_add_u32 s12, s12, s67
  s_and_b32 s13, s65, 1
  s_lshl_b32 s13, s13, 2
  s_and_b32 s67, s66, 3
  s_xor_b32 s67, s67, 3
  s_add_u32 s13, s13, s67
  s_mov_b32 s14, 0
  s_mov_b32 s15, 16
  s_cmp_eq_u32 s40, 1
  s_cselect_b32 s14, 16, s14
  s_cselect_b32 s15, 15, s15
  s_cmp_eq_u32 s40, 2
  s_cselect_b32 s14, 31, s14
  s_cselect_b32 s15, 14, s15
  s_cmp_eq_u32 s40, 3
  s_cselect_b32 s14, 45, s14
  s_cselect_b32 s15, 14, s15
  s_lshl_b32 s96, s40, 14
  s_add_u32 s96, s96, 86016
  s_lshl_b32 s97, s40, 13
  s_mul_i32 s65, s40, 12288
  s_add_u32 s65, s65, 43008
  s_add_u32 s98, s65, 0
  s_add_u32 s99, s65, 4096
  s_add_u32 s100, s65, 8192
  s_cmp_eq_u32 s40, 3
  s_cselect_b32 s99, 151552, s99
  s_cselect_b32 s100, 155648, s100
  s_mul_i32 s101, s40, 28672
  s_add_u32 m0, m0, 1024
  s_nop 0
  buffer_load_dwordx4 v17, s[16:19], s59 offen lds
  s_sub_u32 s65, s14, 16
  s_lshl_b32 s65, s65, 15
  s_add_u32 s67, s44, s65
  s_addc_u32 s68, s45, 0
  s_cmp_eq_u32 s40, 0
  s_cselect_b32 s24, s8, s67
  s_cselect_b32 s25, s9, s68
  s_and_b32 s25, s25, 0xffff
  s_lshl_b32 s26, s15, 15
  s_mov_b32 s27, 0x00020000
  s_mul_i32 s65, s14, 131072
  s_add_u32 s28, s10, s65
  s_addc_u32 s29, s11, 0
  s_and_b32 s29, s29, 0xffff
  s_mul_i32 s30, s15, 131072
  s_mov_b32 s31, 0x00020000
  s_and_b32 s65, s12, 7
  s_mul_i32 s65, s65, 2
  s_and_b32 s66, s13, 3
  s_mul_i32 s66, s66, 0
  s_add_u32 s65, s65, s66
  s_sub_u32 s66, s65, s15
  s_cmp_ge_u32 s65, s15
  s_cselect_b32 s44, s66, s65
  s_mov_b32 s8, s44
  v_lshrrev_b32 v7, 3, v1
  s_add_u32 m0, m0, 1024
  s_nop 0
  buffer_load_dwordx4 v18, s[16:19], s59 offen lds
  v_and_b32 v8, 7, v1
  v_lshlrev_b32 v9, 1, v2
  v_xor_b32 v8, v8, v9
  v_lshlrev_b32 v8, 4, v8
  v_lshl_add_u32 v7, v7, 10, v8
  s_lshl_b32 s65, s13, 7
  v_add_u32 v87, s65, v7
  v_bfe_u32 v7, v1, 2, 2
  v_and_b32 v8, 3, v1
  v_lshl_add_u32 v9, v2, 2, v7
  v_bfe_u32 v10, v9, 1, 2
  v_lshlrev_b32 v10, 1, v10
  v_lshlrev_b32 v9, 7, v9
  v_and_b32 v11, 1, v8
  v_lshl_add_u32 v9, v11, 3, v9
  v_lshrrev_b32 v11, 1, v8
  v_xor_b32 v10, v10, v11
  v_xor_b32 v11, 0, v10
  v_lshl_add_u32 v88, v11, 4, v9
  v_xor_b32 v11, 2, v10
  v_lshl_add_u32 v89, v11, 4, v9
  s_add_u32 m0, m0, 1024
  s_nop 0
  buffer_load_dwordx4 v19, s[16:19], s59 offen lds
  s_add_u32 s59, s59, 128
  s_and_b32 s59, s59, 1023
  v_xor_b32 v11, 4, v10
  v_lshl_add_u32 v90, v11, 4, v9
  v_xor_b32 v11, 6, v10
  v_lshl_add_u32 v91, v11, 4, v9
  s_lshr_b32 s65, s12, 1
  s_lshl_b32 s65, s65, 4
  v_mov_b32 v43, s65
  s_lshl_b32 s65, s12, 2
  s_add_u32 s65, s65, s40
  s_lshl_b32 s65, s65, 6
  v_lshlrev_b32 v7, 2, v3
  v_add_u32 v92, s65, v7
  s_lshl_b32 s65, s65, 8
  s_lshl_b32 s66, s13, 7
  s_add_u32 s65, s65, s66
  v_and_b32 v7, 1, v2
  v_lshlrev_b32 v7, 5, v7
  v_lshrrev_b32 v8, 1, v2
  v_lshl_add_u32 v7, v8, 4, v7
  v_lshl_add_u32 v7, v3, 10, v7
  v_add_u32 v93, s65, v7
  v_add_u32 v35, s54, v27
  v_add_u32 v37, s54, v29
  v_add_u32 v38, s54, v30
  v_add_u32 v36, s54, v28
  v_add_u32 v208, s54, v29
  v_add_u32 v209, s54, v30
  s_mov_b32 s46, 0xaaaaaaaa
  s_mov_b32 s47, 0xaaaaaaaa
  s_mov_b32 s0, 0x3eb8aa3b
  s_mov_b32 s1, 0x3eb8aa3b
  v_and_b32 v8, 14, v3
  v_lshlrev_b32 v9, 2, v2
  v_sub_u32 v8, v8, v9
  v_mov_b32 v9, 0xf149f2ca
  v_add_u32 v10, 0, v8
  v_cmp_gt_u32 s[6:7], 15, v10
  s_nop 1
  v_cndmask_b32 v70, v9, 0, s[6:7]
  v_add_u32 v10, -2, v8
  v_cmp_gt_u32 s[6:7], 15, v10
  s_nop 1
  v_cndmask_b32 v71, v9, 0, s[6:7]
  v_add_u32 v10, 16, v8
  v_cmp_gt_u32 s[6:7], 15, v10
  s_nop 1
  v_cndmask_b32 v72, v9, 0, s[6:7]
  v_add_u32 v10, 14, v8
  v_cmp_gt_u32 s[6:7], 15, v10
  s_nop 1
  v_cndmask_b32 v73, v9, 0, s[6:7]
  s_or_b32 s65, s41, s52
  s_cmp_eq_u32 s65, 0
  s_cselect_b64 s[6:7], -1, 0
  v_cndmask_b32 v74, v72, v9, s[6:7]
  v_cndmask_b32 v75, v73, v9, s[6:7]
  v_mov_b32 v76, 0x0c0c0100
  v_mov_b32 v10, 0x01000c0c
  v_cndmask_b32 v76, v76, v10, s[46:47]
  v_mov_b32 v77, 0x0c0c0302
  v_mov_b32 v10, 0x03020c0c
  v_cndmask_b32 v77, v77, v10, s[46:47]
  v_mov_b32 v78, 0x3f803f80
  v_mov_b32 v79, 0x3f803f80
  v_mov_b32 v80, 0x3f803f80
  v_mov_b32 v81, 0x3f803f80
  s_lshl_b32 s71, s43, 1
  s_add_u32 s71, s71, s53
  s_mul_i32 s71, s71, 131072
  s_lshl_b32 s65, s41, 3
  s_lshl_b32 s66, s52, 2
  s_add_u32 s65, s65, s66
  s_lshl_b32 s65, s65, 10
  v_lshlrev_b32 v250, 4, v1
  v_add_u32 v250, s65, v250
  s_waitcnt vmcnt(4)
  s_barrier
  ds_read_b64_tr_b16 a[28:29], v37 offset:8192
  ds_read_b64_tr_b16 a[30:31], v37 offset:8704
  ds_read_b128 a[0:3], v35 offset:0
  ds_read_b128 a[4:7], v35 offset:2048
  ds_read_b128 a[8:11], v35 offset:4096
  ds_read_b64_tr_b16 a[32:33], v38 offset:8192
  ds_read_b64_tr_b16 a[34:35], v38 offset:8704
  ds_read_b128 a[12:15], v35 offset:6144
  ds_read_b128 a[16:19], v35 offset:8192
  ds_read_b64_tr_b16 a[20:21], v37 offset:0
  ds_read_b64_tr_b16 a[22:23], v37 offset:512
  ds_read_b64_tr_b16 a[24:25], v38 offset:0
  ds_read_b64_tr_b16 a[26:27], v38 offset:512
  ds_read_b64_tr_b16 a[36:37], v37 offset:16384
  ds_read_b64_tr_b16 a[38:39], v37 offset:16896
  ds_read_b64_tr_b16 a[40:41], v38 offset:16384
  ds_read_b64_tr_b16 a[42:43], v38 offset:16896
  s_waitcnt lgkmcnt(0)
  v_mfma_f32_16x16x32_bf16 v[128:131], a[28:31], a[0:3], 0
  ds_read_b64_tr_b16 a[72:73], v208 offset:12288
  s_add_u32 m0, s63, s58
  v_dot2_f32_bf16 v56, v44, v52, 0
  v_dot2_f32_bf16 v57, v48, v52, 0
  v_mfma_f32_16x16x32_bf16 v[136:139], a[28:31], a[4:7], 0
  ds_read_b64_tr_b16 a[74:75], v208 offset:12800
  buffer_load_dwordx4 v21, s[20:23], s60 offen lds
  v_dot2_f32_bf16 v56, v45, v53, v56
  v_mfma_f32_16x16x32_bf16 v[144:147], a[28:31], a[8:11], 0
  ds_read_b128 a[44:47], v36 offset:0
  s_add_u32 m0, m0, 1024
  v_dot2_f32_bf16 v57, v49, v53, v57
  v_dot2_f32_bf16 v56, v46, v54, v56
  v_mfma_f32_16x16x32_bf16 v[152:155], a[28:31], a[12:15], 0
  ds_read_b128 a[48:51], v36 offset:2048
  buffer_load_dwordx4 v22, s[20:23], s60 offen lds
  v_dot2_f32_bf16 v57, v50, v54, v57
  v_mfma_f32_16x16x32_bf16 v[160:163], a[28:31], a[16:19], 0
  ds_read_b128 a[52:55], v36 offset:4096
  s_add_u32 m0, m0, 1024
  v_dot2_f32_bf16 v56, v47, v55, v56
  v_mfma_f32_16x16x32_bf16 v[132:135], a[32:35], a[0:3], 0
  ds_read_b64_tr_b16 a[76:77], v209 offset:12288
  buffer_load_dwordx4 v23, s[20:23], s60 offen lds
  v_dot2_f32_bf16 v57, v51, v55, v57
  s_nop 0
  v_mfma_f32_16x16x32_bf16 v[140:143], a[32:35], a[4:7], 0
  s_nop 0
  v_mfma_f32_16x16x32_bf16 v[148:151], a[32:35], a[8:11], 0
  ds_read_b64_tr_b16 a[78:79], v209 offset:12800
  s_add_u32 m0, m0, 1024
  v_add_f32_dpp v56, v56, v56 row_ror:8 row_mask:0xf bank_mask:0xf
  v_add_f32_dpp v57, v57, v57 row_ror:8 row_mask:0xf bank_mask:0xf
  v_mfma_f32_16x16x32_bf16 v[156:159], a[32:35], a[12:15], 0
  ds_read_b128 a[56:59], v36 offset:6144
  buffer_load_dwordx4 v24, s[20:23], s60 offen lds
  v_add_f32_dpp v56, v56, v56 row_ror:4 row_mask:0xf bank_mask:0xf
  v_mfma_f32_16x16x32_bf16 v[164:167], a[32:35], a[16:19], 0
  ds_read_b128 a[60:63], v36 offset:8192
  s_add_u32 m0, m0, 1024
  v_add_f32_dpp v57, v57, v57 row_ror:4 row_mask:0xf bank_mask:0xf
  v_mfma_f32_16x16x32_bf16 v[96:99], a[20:23], a[4:7], 0
  ds_read_b64_tr_b16 a[64:65], v208 offset:4096
  buffer_load_dwordx4 v25, s[20:23], s60 offen lds
  v_add_f32_dpp v56, v56, v56 row_ror:2 row_mask:0xf bank_mask:0xf
  v_add_f32_dpp v57, v57, v57 row_ror:2 row_mask:0xf bank_mask:0xf
  v_mfma_f32_16x16x32_bf16 v[104:107], a[20:23], a[8:11], 0
  ds_read_b64_tr_b16 a[66:67], v208 offset:4608
  v_add_f32_dpp v56, v56, v56 row_ror:1 row_mask:0xf bank_mask:0xf
  v_mfma_f32_16x16x32_bf16 v[112:115], a[20:23], a[12:15], 0
  ds_read_b64_tr_b16 a[68:69], v209 offset:4096
  s_add_u32 m0, m0, 1024
  v_add_f32_dpp v57, v57, v57 row_ror:1 row_mask:0xf bank_mask:0xf
  v_mov_b32 v4, v56
  v_mfma_f32_16x16x32_bf16 v[120:123], a[20:23], a[16:19], 0
  buffer_load_dwordx4 v26, s[20:23], s60 offen lds
  s_add_u32 s60, s60, s62
  s_cmp_eq_u32 s60, s22
  s_cselect_b32 s60, 0, s60
  v_mov_b32 v5, v57
  v_mfma_f32_16x16x32_bf16 v[100:103], a[24:27], a[4:7], 0
  ds_read_b64_tr_b16 a[70:71], v209 offset:4608
  s_add_u32 m0, s55, s57
  v_permlane16_swap_b32 v56, v4
  v_mfma_f32_16x16x32_bf16 v[108:111], a[24:27], a[8:11], 0
  ds_read_b64_tr_b16 a[80:81], v208 offset:20480
  s_cmp_eq_u32 s3, 1
  s_cbranch_scc0 1f
  buffer_load_dwordx4 v20, s[16:19], s59 offen lds
1:
  v_permlane16_swap_b32 v57, v5
  v_add_u32 v35, s63, v27
  v_mfma_f32_16x16x32_bf16 v[116:119], a[24:27], a[12:15], 0
  ds_read_b64_tr_b16 a[82:83], v208 offset:20992
  v_add_u32 v37, s63, v29
  v_mfma_f32_16x16x32_bf16 v[124:127], a[24:27], a[16:19], 0
  ds_read_b64_tr_b16 a[84:85], v209 offset:20480
  s_add_u32 m0, s55, s56
  v_add_u32 v38, s63, v30
  v_mfma_f32_16x16x32_bf16 v[168:171], a[0:3], a[36:39], 0
  ds_read_b64_tr_b16 a[86:87], v209 offset:20992
  buffer_load_dwordx4 v16, s[16:19], s59 offen lds
  v_mfma_f32_16x16x32_bf16 v[176:179], a[4:7], a[36:39], 0
  s_add_u32 m0, m0, 1024
  v_mfma_f32_16x16x32_bf16 v[184:187], a[8:11], a[36:39], 0
  buffer_load_dwordx4 v17, s[16:19], s59 offen lds
  v_mfma_f32_16x16x32_bf16 v[192:195], a[12:15], a[36:39], 0
  v_mfma_f32_16x16x32_bf16 v[200:203], a[16:19], a[36:39], 0
  s_add_u32 m0, m0, 1024
  v_mfma_f32_16x16x32_bf16 v[172:175], a[0:3], a[40:43], 0
  buffer_load_dwordx4 v18, s[16:19], s59 offen lds
  v_mfma_f32_16x16x32_bf16 v[180:183], a[4:7], a[40:43], 0
  s_add_u32 m0, m0, 1024
  v_mfma_f32_16x16x32_bf16 v[188:191], a[8:11], a[40:43], 0
  buffer_load_dwordx4 v19, s[16:19], s59 offen lds
  s_add_u32 s59, s59, 128
  s_and_b32 s59, s59, 1023
  v_mfma_f32_16x16x32_bf16 v[196:199], a[12:15], a[40:43], 0
  v_mfma_f32_16x16x32_bf16 v[204:207], a[16:19], a[40:43], 0
  s_waitcnt vmcnt(4) lgkmcnt(0)
  s_barrier
  v_mfma_f32_16x16x32_bf16 v[128:131], a[72:75], a[44:47], v[128:131]
  ds_read_b64_tr_b16 a[28:29], v37 offset:8192
  v_add_f32 v56, v56, v4
  v_mfma_f32_16x16x32_bf16 v[136:139], a[72:75], a[48:51], v[136:139]
  ds_read_b64_tr_b16 a[30:31], v37 offset:8704
  s_add_u32 m0, s55, s58
  v_add_f32 v57, v57, v5
  v_mfma_f32_16x16x32_bf16 v[144:147], a[72:75], a[52:55], v[144:147]
  ds_read_b128 a[0:3], v35 offset:0
  buffer_load_dwordx4 v21, s[20:23], s60 offen lds
  v_mov_b32 v4, v56
  v_mfma_f32_16x16x32_bf16 v[152:155], a[72:75], a[56:59], v[152:155]
  ds_read_b128 a[4:7], v35 offset:2048
  s_add_u32 m0, m0, 1024
  v_mov_b32 v5, v57
  v_mfma_f32_16x16x32_bf16 v[160:163], a[72:75], a[60:63], v[160:163]
  ds_read_b128 a[8:11], v35 offset:4096
  buffer_load_dwordx4 v22, s[20:23], s60 offen lds
  v_permlane32_swap_b32 v56, v4
  v_mfma_f32_16x16x32_bf16 v[132:135], a[76:79], a[44:47], v[132:135]
  ds_read_b64_tr_b16 a[32:33], v38 offset:8192
  s_add_u32 m0, m0, 1024
  v_permlane32_swap_b32 v57, v5
  v_mfma_f32_16x16x32_bf16 v[140:143], a[76:79], a[48:51], v[140:143]
  buffer_load_dwordx4 v23, s[20:23], s60 offen lds
  v_add_f32 v56, v56, v4
  v_mfma_f32_16x16x32_bf16 v[148:151], a[76:79], a[52:55], v[148:151]
  ds_read_b64_tr_b16 a[34:35], v38 offset:8704
  v_add_f32 v57, v57, v5
  v_mfma_f32_16x16x32_bf16 v[156:159], a[76:79], a[56:59], v[156:159]
  ds_read_b128 a[12:15], v35 offset:6144
  s_add_u32 m0, m0, 1024
  v_mul_f32 v56, 0xbfb8aa3b, v56
  v_mfma_f32_16x16x32_bf16 v[164:167], a[76:79], a[60:63], v[164:167]
  ds_read_b128 a[16:19], v35 offset:8192
  buffer_load_dwordx4 v24, s[20:23], s60 offen lds
  v_mul_f32 v57, 0xbfb8aa3b, v57
  v_mfma_f32_16x16x32_bf16 v[96:99], a[64:67], a[48:51], v[96:99]
  ds_read_b64_tr_b16 a[20:21], v37 offset:0
  s_add_u32 m0, m0, 1024
  v_exp_f32 v56, v56
  v_mfma_f32_16x16x32_bf16 v[104:107], a[64:67], a[52:55], v[104:107]
  ds_read_b64_tr_b16 a[22:23], v37 offset:512
  buffer_load_dwordx4 v25, s[20:23], s60 offen lds
  v_exp_f32 v57, v57
  v_mfma_f32_16x16x32_bf16 v[112:115], a[64:67], a[56:59], v[112:115]
  ds_read_b64_tr_b16 a[24:25], v38 offset:0
  s_add_u32 m0, m0, 1024
  v_add_f32 v56, 1.0, v56
  v_mfma_f32_16x16x32_bf16 v[120:123], a[64:67], a[60:63], v[120:123]
  buffer_load_dwordx4 v26, s[20:23], s60 offen lds
  s_add_u32 s60, s60, s62
  s_cmp_eq_u32 s60, s22
  s_cselect_b32 s60, 0, s60
  v_add_f32 v57, 1.0, v57
  v_mfma_f32_16x16x32_bf16 v[100:103], a[68:71], a[48:51], v[100:103]
  ds_read_b64_tr_b16 a[26:27], v38 offset:512
  v_rcp_f32 v56, v56
  v_mfma_f32_16x16x32_bf16 v[108:111], a[68:71], a[52:55], v[108:111]
  ds_read_b64_tr_b16 a[36:37], v37 offset:16384
  s_add_u32 m0, s54, s57
  v_rcp_f32 v57, v57
  v_mfma_f32_16x16x32_bf16 v[116:119], a[68:71], a[56:59], v[116:119]
  ds_read_b64_tr_b16 a[38:39], v37 offset:16896
  s_cmp_eq_u32 s3, 1
  s_cbranch_scc0 1f
  buffer_load_dwordx4 v20, s[16:19], s59 offen lds
1:
  v_add_u32 v36, s63, v28
  v_mfma_f32_16x16x32_bf16 v[124:127], a[68:71], a[60:63], v[124:127]
  ds_read_b64_tr_b16 a[40:41], v38 offset:16384
  s_add_u32 m0, s54, s56
  v_add_u32 v208, s63, v29
  v_mfma_f32_16x16x32_bf16 v[168:171], a[44:47], a[80:83], v[168:171]
  ds_read_b64_tr_b16 a[42:43], v38 offset:16896
  buffer_load_dwordx4 v16, s[16:19], s59 offen lds
  v_add_u32 v209, s63, v30
  v_mfma_f32_16x16x32_bf16 v[176:179], a[48:51], a[80:83], v[176:179]
  s_add_u32 m0, m0, 1024
  v_mfma_f32_16x16x32_bf16 v[184:187], a[52:55], a[80:83], v[184:187]
  buffer_load_dwordx4 v17, s[16:19], s59 offen lds
  v_mfma_f32_16x16x32_bf16 v[192:195], a[56:59], a[80:83], v[192:195]
  v_mfma_f32_16x16x32_bf16 v[200:203], a[60:63], a[80:83], v[200:203]
  s_add_u32 m0, m0, 1024
  v_mfma_f32_16x16x32_bf16 v[172:175], a[44:47], a[84:87], v[172:175]
  buffer_load_dwordx4 v18, s[16:19], s59 offen lds
  v_mfma_f32_16x16x32_bf16 v[180:183], a[48:51], a[84:87], v[180:183]
  s_add_u32 m0, m0, 1024
  v_mfma_f32_16x16x32_bf16 v[188:191], a[52:55], a[84:87], v[188:191]
  buffer_load_dwordx4 v19, s[16:19], s59 offen lds
  s_add_u32 s59, s59, 128
  s_and_b32 s59, s59, 1023
  s_mov_b32 s65, s55
  s_mov_b32 s55, s54
  v_mfma_f32_16x16x32_bf16 v[196:199], a[56:59], a[84:87], v[196:199]
  s_mov_b32 s54, s63
  s_mov_b32 s63, s65
  v_mfma_f32_16x16x32_bf16 v[204:207], a[60:63], a[84:87], v[204:207]
  s_waitcnt lgkmcnt(0)
  v_mfma_f32_16x16x32_bf16 v[128:131], a[28:31], a[0:3], v[128:131]
  ds_read_b64_tr_b16 a[72:73], v208 offset:12288
  v_add_u32 v35, s63, v27
  v_mfma_f32_16x16x32_bf16 v[136:139], a[28:31], a[4:7], v[136:139]
  ds_read_b64_tr_b16 a[74:75], v208 offset:12800
  s_add_u32 m0, s55, s58
  v_mfma_f32_16x16x32_bf16 v[144:147], a[28:31], a[8:11], v[144:147]
  ds_read_b128 a[44:47], v36 offset:0
  buffer_load_dwordx4 v21, s[20:23], s60 offen lds
  v_mfma_f32_16x16x32_bf16 v[152:155], a[28:31], a[12:15], v[152:155]
  ds_read_b128 a[48:51], v36 offset:2048
  v_mfma_f32_16x16x32_bf16 v[160:163], a[28:31], a[16:19], v[160:163]
  ds_read_b128 a[52:55], v36 offset:4096
  v_mfma_f32_16x16x32_bf16 v[132:135], a[32:35], a[0:3], v[132:135]
  ds_read_b64_tr_b16 a[76:77], v209 offset:12288
  s_add_u32 m0, m0, 1024
  v_mfma_f32_16x16x32_bf16 v[140:143], a[32:35], a[4:7], v[140:143]
  buffer_load_dwordx4 v22, s[20:23], s60 offen lds
  v_add_u32 v37, s63, v29
  v_mfma_f32_16x16x32_bf16 v[148:151], a[32:35], a[8:11], v[148:151]
  ds_read_b64_tr_b16 a[78:79], v209 offset:12800
  v_mfma_f32_16x16x32_bf16 v[156:159], a[32:35], a[12:15], v[156:159]
  ds_read_b128 a[56:59], v36 offset:6144
  v_mfma_f32_16x16x32_bf16 v[164:167], a[32:35], a[16:19], v[164:167]
  ds_read_b128 a[60:63], v36 offset:8192
  s_add_u32 m0, m0, 1024
  v_mfma_f32_16x16x32_bf16 v[96:99], a[20:23], a[4:7], v[96:99]
  ds_read_b64_tr_b16 a[64:65], v208 offset:4096
  buffer_load_dwordx4 v23, s[20:23], s60 offen lds
  v_mfma_f32_16x16x32_bf16 v[104:107], a[20:23], a[8:11], v[104:107]
  ds_read_b64_tr_b16 a[66:67], v208 offset:4608
  v_mfma_f32_16x16x32_bf16 v[112:115], a[20:23], a[12:15], v[112:115]
  ds_read_b64_tr_b16 a[68:69], v209 offset:4096
  v_add_u32 v38, s63, v30
  v_mfma_f32_16x16x32_bf16 v[120:123], a[20:23], a[16:19], v[120:123]
  v_mfma_f32_16x16x32_bf16 v[100:103], a[24:27], a[4:7], v[100:103]
  ds_read_b64_tr_b16 a[70:71], v209 offset:4608
  s_add_u32 m0, m0, 1024
  v_mfma_f32_16x16x32_bf16 v[108:111], a[24:27], a[8:11], v[108:111]
  ds_read_b64_tr_b16 a[80:81], v208 offset:20480
  buffer_load_dwordx4 v24, s[20:23], s60 offen lds
  v_mfma_f32_16x16x32_bf16 v[116:119], a[24:27], a[12:15], v[116:119]
  ds_read_b64_tr_b16 a[82:83], v208 offset:20992
  v_mfma_f32_16x16x32_bf16 v[124:127], a[24:27], a[16:19], v[124:127]
  ds_read_b64_tr_b16 a[84:85], v209 offset:20480
  v_mfma_f32_16x16x32_bf16 v[168:171], a[0:3], a[36:39], v[168:171]
  ds_read_b64_tr_b16 a[86:87], v209 offset:20992
  s_add_u32 m0, m0, 1024
  v_mfma_f32_16x16x32_bf16 v[176:179], a[4:7], a[36:39], v[176:179]
  buffer_load_dwordx4 v25, s[20:23], s60 offen lds
  v_mfma_f32_16x16x32_bf16 v[184:187], a[8:11], a[36:39], v[184:187]
  v_mfma_f32_16x16x32_bf16 v[192:195], a[12:15], a[36:39], v[192:195]
  v_mfma_f32_16x16x32_bf16 v[200:203], a[16:19], a[36:39], v[200:203]
  s_add_u32 m0, m0, 1024
  v_mfma_f32_16x16x32_bf16 v[172:175], a[0:3], a[40:43], v[172:175]
  buffer_load_dwordx4 v26, s[20:23], s60 offen lds
  s_add_u32 s60, s60, s62
  s_cmp_eq_u32 s60, s22
  s_cselect_b32 s60, 0, s60
  v_mfma_f32_16x16x32_bf16 v[180:183], a[4:7], a[40:43], v[180:183]
  v_mfma_f32_16x16x32_bf16 v[188:191], a[8:11], a[40:43], v[188:191]
  v_mfma_f32_16x16x32_bf16 v[196:199], a[12:15], a[40:43], v[196:199]
  v_mfma_f32_16x16x32_bf16 v[204:207], a[16:19], a[40:43], v[204:207]
  s_waitcnt vmcnt(10) lgkmcnt(0)
  s_barrier
  v_mfma_f32_16x16x32_bf16 v[128:131], a[72:75], a[44:47], v[128:131]
  ds_read_b64_tr_b16 a[28:29], v37 offset:8192
  v_mov_b32 v7, 1
  s_and_saveexec_b64 s[6:7], s[4:5]
  s_cbranch_execz 2f
  global_atomic_add v95, v7, s[50:51] sc1
2:
  s_mov_b64 exec, s[6:7]
  v_mfma_f32_16x16x32_bf16 v[136:139], a[72:75], a[48:51], v[136:139]
  ds_read_b64_tr_b16 a[30:31], v37 offset:8704
  s_add_u32 m0, s54, s57
  v_mfma_f32_16x16x32_bf16 v[144:147], a[72:75], a[52:55], v[144:147]
  ds_read_b128 a[0:3], v35 offset:0
  s_cmp_eq_u32 s3, 1
  s_cbranch_scc0 1f
  buffer_load_dwordx4 v20, s[16:19], s59 offen lds
1:
  v_mfma_f32_16x16x32_bf16 v[152:155], a[72:75], a[56:59], v[152:155]
  ds_read_b128 a[4:7], v35 offset:2048
  v_mfma_f32_16x16x32_bf16 v[160:163], a[72:75], a[60:63], v[160:163]
  ds_read_b128 a[8:11], v35 offset:4096
  v_mfma_f32_16x16x32_bf16 v[132:135], a[76:79], a[44:47], v[132:135]
  ds_read_b64_tr_b16 a[32:33], v38 offset:8192
  s_add_u32 m0, s54, s56
  v_add_u32 v36, s63, v28
  v_mfma_f32_16x16x32_bf16 v[140:143], a[76:79], a[48:51], v[140:143]
  buffer_load_dwordx4 v16, s[16:19], s59 offen lds
  v_mfma_f32_16x16x32_bf16 v[148:151], a[76:79], a[52:55], v[148:151]
  ds_read_b64_tr_b16 a[34:35], v38 offset:8704
  v_mfma_f32_16x16x32_bf16 v[156:159], a[76:79], a[56:59], v[156:159]
  ds_read_b128 a[12:15], v35 offset:6144
  v_mfma_f32_16x16x32_bf16 v[164:167], a[76:79], a[60:63], v[164:167]
  ds_read_b128 a[16:19], v35 offset:8192
  s_add_u32 m0, m0, 1024
  v_mfma_f32_16x16x32_bf16 v[96:99], a[64:67], a[48:51], v[96:99]
  ds_read_b64_tr_b16 a[20:21], v37 offset:0
  buffer_load_dwordx4 v17, s[16:19], s59 offen lds
  v_add_u32 v208, s63, v29
  v_mfma_f32_16x16x32_bf16 v[104:107], a[64:67], a[52:55], v[104:107]
  ds_read_b64_tr_b16 a[22:23], v37 offset:512
  v_mfma_f32_16x16x32_bf16 v[112:115], a[64:67], a[56:59], v[112:115]
  ds_read_b64_tr_b16 a[24:25], v38 offset:0
  v_mfma_f32_16x16x32_bf16 v[120:123], a[64:67], a[60:63], v[120:123]
  v_mfma_f32_16x16x32_bf16 v[100:103], a[68:71], a[48:51], v[100:103]
  ds_read_b64_tr_b16 a[26:27], v38 offset:512
  s_add_u32 m0, m0, 1024
  v_mfma_f32_16x16x32_bf16 v[108:111], a[68:71], a[52:55], v[108:111]
  ds_read_b64_tr_b16 a[36:37], v37 offset:16384
  buffer_load_dwordx4 v18, s[16:19], s59 offen lds
  v_add_u32 v209, s63, v30
  v_mfma_f32_16x16x32_bf16 v[116:119], a[68:71], a[56:59], v[116:119]
  ds_read_b64_tr_b16 a[38:39], v37 offset:16896
  v_mfma_f32_16x16x32_bf16 v[124:127], a[68:71], a[60:63], v[124:127]
  ds_read_b64_tr_b16 a[40:41], v38 offset:16384
  v_mfma_f32_16x16x32_bf16 v[168:171], a[44:47], a[80:83], v[168:171]
  ds_read_b64_tr_b16 a[42:43], v38 offset:16896
  s_add_u32 m0, m0, 1024
  v_mfma_f32_16x16x32_bf16 v[176:179], a[48:51], a[80:83], v[176:179]
  buffer_load_dwordx4 v19, s[16:19], s59 offen lds
  v_mfma_f32_16x16x32_bf16 v[184:187], a[52:55], a[80:83], v[184:187]
  v_mfma_f32_16x16x32_bf16 v[192:195], a[56:59], a[80:83], v[192:195]
  v_mfma_f32_16x16x32_bf16 v[200:203], a[60:63], a[80:83], v[200:203]
  s_add_u32 m0, s54, s58
  v_mfma_f32_16x16x32_bf16 v[172:175], a[44:47], a[84:87], v[172:175]
  buffer_load_dwordx4 v21, s[20:23], s60 offen lds
  v_mfma_f32_16x16x32_bf16 v[180:183], a[48:51], a[84:87], v[180:183]
  s_mov_b32 s61, s60
  s_add_u32 s59, s59, 128
  s_and_b32 s59, s59, 1023
  s_add_u32 s60, s60, s62
  s_cmp_eq_u32 s60, s22
  s_cselect_b32 s60, 0, s60
  v_mfma_f32_16x16x32_bf16 v[188:191], a[52:55], a[84:87], v[188:191]
  s_mov_b32 s65, s55
  s_mov_b32 s55, s54
  v_mfma_f32_16x16x32_bf16 v[196:199], a[56:59], a[84:87], v[196:199]
  s_mov_b32 s54, s63
  s_mov_b32 s63, s65
  v_mfma_f32_16x16x32_bf16 v[204:207], a[60:63], a[84:87], v[204:207]
  s_waitcnt lgkmcnt(0)
  s_mov_b32 s66, 2
Latt_loop:
  v_mfma_f32_16x16x32_bf16 v[128:131], a[28:31], a[0:3], v[128:131]
  ds_read_b64_tr_b16 a[72:73], v208 offset:12288
  v_add_u32 v35, s63, v27
  v_mfma_f32_16x16x32_bf16 v[136:139], a[28:31], a[4:7], v[136:139]
  ds_read_b64_tr_b16 a[74:75], v208 offset:12800
  s_add_u32 m0, s55, s58
  s_add_u32 m0, m0, 1024
  v_mfma_f32_16x16x32_bf16 v[144:147], a[28:31], a[8:11], v[144:147]
  ds_read_b128 a[44:47], v36 offset:0
  buffer_load_dwordx4 v22, s[20:23], s61 offen lds
  v_mfma_f32_16x16x32_bf16 v[152:155], a[28:31], a[12:15], v[152:155]
  ds_read_b128 a[48:51], v36 offset:2048
  v_mfma_f32_16x16x32_bf16 v[160:163], a[28:31], a[16:19], v[160:163]
  ds_read_b128 a[52:55], v36 offset:4096
  v_mfma_f32_16x16x32_bf16 v[132:135], a[32:35], a[0:3], v[132:135]
  ds_read_b64_tr_b16 a[76:77], v209 offset:12288
  v_mfma_f32_16x16x32_bf16 v[140:143], a[32:35], a[4:7], v[140:143]
  s_add_u32 m0, m0, 1024
  v_add_u32 v37, s63, v29
  v_mfma_f32_16x16x32_bf16 v[148:151], a[32:35], a[8:11], v[148:151]
  ds_read_b64_tr_b16 a[78:79], v209 offset:12800
  buffer_load_dwordx4 v23, s[20:23], s61 offen lds
  v_mfma_f32_16x16x32_bf16 v[156:159], a[32:35], a[12:15], v[156:159]
  ds_read_b128 a[56:59], v36 offset:6144
  v_mfma_f32_16x16x32_bf16 v[164:167], a[32:35], a[16:19], v[164:167]
  ds_read_b128 a[60:63], v36 offset:8192
  v_mfma_f32_16x16x32_bf16 v[96:99], a[20:23], a[4:7], v[96:99]
  ds_read_b64_tr_b16 a[64:65], v208 offset:4096
  v_mfma_f32_16x16x32_bf16 v[104:107], a[20:23], a[8:11], v[104:107]
  ds_read_b64_tr_b16 a[66:67], v208 offset:4608
  s_add_u32 m0, m0, 1024
  v_mfma_f32_16x16x32_bf16 v[112:115], a[20:23], a[12:15], v[112:115]
  ds_read_b64_tr_b16 a[68:69], v209 offset:4096
  buffer_load_dwordx4 v24, s[20:23], s61 offen lds
  v_add_u32 v38, s63, v30
  v_mfma_f32_16x16x32_bf16 v[120:123], a[20:23], a[16:19], v[120:123]
  v_mfma_f32_16x16x32_bf16 v[100:103], a[24:27], a[4:7], v[100:103]
  ds_read_b64_tr_b16 a[70:71], v209 offset:4608
  v_mfma_f32_16x16x32_bf16 v[108:111], a[24:27], a[8:11], v[108:111]
  ds_read_b64_tr_b16 a[80:81], v208 offset:20480
  v_mfma_f32_16x16x32_bf16 v[116:119], a[24:27], a[12:15], v[116:119]
  ds_read_b64_tr_b16 a[82:83], v208 offset:20992
  s_add_u32 m0, m0, 1024
  v_mfma_f32_16x16x32_bf16 v[124:127], a[24:27], a[16:19], v[124:127]
  ds_read_b64_tr_b16 a[84:85], v209 offset:20480
  buffer_load_dwordx4 v25, s[20:23], s61 offen lds
  v_mfma_f32_16x16x32_bf16 v[168:171], a[0:3], a[36:39], v[168:171]
  ds_read_b64_tr_b16 a[86:87], v209 offset:20992
  v_mfma_f32_16x16x32_bf16 v[176:179], a[4:7], a[36:39], v[176:179]
  v_mfma_f32_16x16x32_bf16 v[184:187], a[8:11], a[36:39], v[184:187]
  v_mfma_f32_16x16x32_bf16 v[192:195], a[12:15], a[36:39], v[192:195]
  s_add_u32 m0, m0, 1024
  v_mfma_f32_16x16x32_bf16 v[200:203], a[16:19], a[36:39], v[200:203]
  buffer_load_dwordx4 v26, s[20:23], s61 offen lds
  v_mfma_f32_16x16x32_bf16 v[172:175], a[0:3], a[40:43], v[172:175]
  v_mfma_f32_16x16x32_bf16 v[180:183], a[4:7], a[40:43], v[180:183]
  v_mfma_f32_16x16x32_bf16 v[188:191], a[8:11], a[40:43], v[188:191]
  v_mfma_f32_16x16x32_bf16 v[196:199], a[12:15], a[40:43], v[196:199]
  v_mfma_f32_16x16x32_bf16 v[204:207], a[16:19], a[40:43], v[204:207]
  s_waitcnt vmcnt(10) lgkmcnt(0)
  s_barrier
  v_mfma_f32_16x16x32_bf16 v[128:131], a[72:75], a[44:47], v[128:131]
  ds_read_b64_tr_b16 a[28:29], v37 offset:8192
  v_add_u32 v36, s63, v28
  v_mfma_f32_16x16x32_bf16 v[136:139], a[72:75], a[48:51], v[136:139]
  ds_read_b64_tr_b16 a[30:31], v37 offset:8704
  s_add_u32 m0, s54, s57
  v_mfma_f32_16x16x32_bf16 v[144:147], a[72:75], a[52:55], v[144:147]
  ds_read_b128 a[0:3], v35 offset:0
  s_cmp_eq_u32 s3, 1
  s_cbranch_scc0 1f
  buffer_load_dwordx4 v20, s[16:19], s59 offen lds
1:
  v_mfma_f32_16x16x32_bf16 v[152:155], a[72:75], a[56:59], v[152:155]
  ds_read_b128 a[4:7], v35 offset:2048
  v_mfma_f32_16x16x32_bf16 v[160:163], a[72:75], a[60:63], v[160:163]
  ds_read_b128 a[8:11], v35 offset:4096
  v_mfma_f32_16x16x32_bf16 v[132:135], a[76:79], a[44:47], v[132:135]
  ds_read_b64_tr_b16 a[32:33], v38 offset:8192
  s_add_u32 m0, s54, s56
  v_mfma_f32_16x16x32_bf16 v[140:143], a[76:79], a[48:51], v[140:143]
  buffer_load_dwordx4 v16, s[16:19], s59 offen lds
  v_add_u32 v208, s63, v29
  v_mfma_f32_16x16x32_bf16 v[148:151], a[76:79], a[52:55], v[148:151]
  ds_read_b64_tr_b16 a[34:35], v38 offset:8704
  v_mfma_f32_16x16x32_bf16 v[156:159], a[76:79], a[56:59], v[156:159]
  ds_read_b128 a[12:15], v35 offset:6144
  v_mfma_f32_16x16x32_bf16 v[164:167], a[76:79], a[60:63], v[164:167]
  ds_read_b128 a[16:19], v35 offset:8192
  s_add_u32 m0, m0, 1024
  v_mfma_f32_16x16x32_bf16 v[96:99], a[64:67], a[48:51], v[96:99]
  ds_read_b64_tr_b16 a[20:21], v37 offset:0
  buffer_load_dwordx4 v17, s[16:19], s59 offen lds
  v_mfma_f32_16x16x32_bf16 v[104:107], a[64:67], a[52:55], v[104:107]
  ds_read_b64_tr_b16 a[22:23], v37 offset:512
  v_mfma_f32_16x16x32_bf16 v[112:115], a[64:67], a[56:59], v[112:115]
  ds_read_b64_tr_b16 a[24:25], v38 offset:0
  v_mfma_f32_16x16x32_bf16 v[120:123], a[64:67], a[60:63], v[120:123]
  v_add_u32 v209, s63, v30
  v_mfma_f32_16x16x32_bf16 v[100:103], a[68:71], a[48:51], v[100:103]
  ds_read_b64_tr_b16 a[26:27], v38 offset:512
  s_add_u32 m0, m0, 1024
  v_mfma_f32_16x16x32_bf16 v[108:111], a[68:71], a[52:55], v[108:111]
  ds_read_b64_tr_b16 a[36:37], v37 offset:16384
  buffer_load_dwordx4 v18, s[16:19], s59 offen lds
  v_mfma_f32_16x16x32_bf16 v[116:119], a[68:71], a[56:59], v[116:119]
  ds_read_b64_tr_b16 a[38:39], v37 offset:16896
  v_mfma_f32_16x16x32_bf16 v[124:127], a[68:71], a[60:63], v[124:127]
  ds_read_b64_tr_b16 a[40:41], v38 offset:16384
  v_mfma_f32_16x16x32_bf16 v[168:171], a[44:47], a[80:83], v[168:171]
  ds_read_b64_tr_b16 a[42:43], v38 offset:16896
  s_add_u32 m0, m0, 1024
  v_mfma_f32_16x16x32_bf16 v[176:179], a[48:51], a[80:83], v[176:179]
  buffer_load_dwordx4 v19, s[16:19], s59 offen lds
  v_mfma_f32_16x16x32_bf16 v[184:187], a[52:55], a[80:83], v[184:187]
  v_mfma_f32_16x16x32_bf16 v[192:195], a[56:59], a[80:83], v[192:195]
  v_mfma_f32_16x16x32_bf16 v[200:203], a[60:63], a[80:83], v[200:203]
  s_add_u32 m0, s54, s58
  v_mfma_f32_16x16x32_bf16 v[172:175], a[44:47], a[84:87], v[172:175]
  buffer_load_dwordx4 v21, s[20:23], s60 offen lds
  s_mov_b32 s61, s60
  s_add_u32 s59, s59, 128
  s_and_b32 s59, s59, 1023
  s_add_u32 s60, s60, s62
  s_cmp_eq_u32 s60, s22
  s_cselect_b32 s60, 0, s60
  v_mfma_f32_16x16x32_bf16 v[180:183], a[48:51], a[84:87], v[180:183]
  s_mov_b32 s65, s55
  s_mov_b32 s55, s54
  v_mfma_f32_16x16x32_bf16 v[188:191], a[52:55], a[84:87], v[188:191]
  s_mov_b32 s54, s63
  s_mov_b32 s63, s65
  v_mfma_f32_16x16x32_bf16 v[196:199], a[56:59], a[84:87], v[196:199]
  s_add_u32 s66, s66, 1
  s_cmp_lt_u32 s66, 5
  v_mfma_f32_16x16x32_bf16 v[204:207], a[60:63], a[84:87], v[204:207]
  s_waitcnt lgkmcnt(0)
  s_cbranch_scc1 Latt_loop
  v_mfma_f32_16x16x32_bf16 v[128:131], a[28:31], a[0:3], v[128:131]
  ds_read_b64_tr_b16 a[72:73], v208 offset:12288
  v_add_u32 v35, s63, v27
  v_mfma_f32_16x16x32_bf16 v[136:139], a[28:31], a[4:7], v[136:139]
  ds_read_b64_tr_b16 a[74:75], v208 offset:12800
  s_add_u32 m0, s55, s58
  s_add_u32 m0, m0, 1024
  v_mfma_f32_16x16x32_bf16 v[144:147], a[28:31], a[8:11], v[144:147]
  ds_read_b128 a[44:47], v36 offset:0
  buffer_load_dwordx4 v22, s[20:23], s61 offen lds
  v_mfma_f32_16x16x32_bf16 v[152:155], a[28:31], a[12:15], v[152:155]
  ds_read_b128 a[48:51], v36 offset:2048
  v_mfma_f32_16x16x32_bf16 v[160:163], a[28:31], a[16:19], v[160:163]
  ds_read_b128 a[52:55], v36 offset:4096
  v_mfma_f32_16x16x32_bf16 v[132:135], a[32:35], a[0:3], v[132:135]
  ds_read_b64_tr_b16 a[76:77], v209 offset:12288
  v_mfma_f32_16x16x32_bf16 v[140:143], a[32:35], a[4:7], v[140:143]
  s_add_u32 m0, m0, 1024
  v_add_u32 v37, s63, v29
  v_mfma_f32_16x16x32_bf16 v[148:151], a[32:35], a[8:11], v[148:151]
  ds_read_b64_tr_b16 a[78:79], v209 offset:12800
  buffer_load_dwordx4 v23, s[20:23], s61 offen lds
  v_mfma_f32_16x16x32_bf16 v[156:159], a[32:35], a[12:15], v[156:159]
  ds_read_b128 a[56:59], v36 offset:6144
  v_mfma_f32_16x16x32_bf16 v[164:167], a[32:35], a[16:19], v[164:167]
  ds_read_b128 a[60:63], v36 offset:8192
  v_mfma_f32_16x16x32_bf16 v[96:99], a[20:23], a[4:7], v[96:99]
  ds_read_b64_tr_b16 a[64:65], v208 offset:4096
  v_mfma_f32_16x16x32_bf16 v[104:107], a[20:23], a[8:11], v[104:107]
  ds_read_b64_tr_b16 a[66:67], v208 offset:4608
  s_add_u32 m0, m0, 1024
  v_mfma_f32_16x16x32_bf16 v[112:115], a[20:23], a[12:15], v[112:115]
  ds_read_b64_tr_b16 a[68:69], v209 offset:4096
  buffer_load_dwordx4 v24, s[20:23], s61 offen lds
  v_add_u32 v38, s63, v30
  v_mfma_f32_16x16x32_bf16 v[120:123], a[20:23], a[16:19], v[120:123]
  v_mfma_f32_16x16x32_bf16 v[100:103], a[24:27], a[4:7], v[100:103]
  ds_read_b64_tr_b16 a[70:71], v209 offset:4608
  v_mfma_f32_16x16x32_bf16 v[108:111], a[24:27], a[8:11], v[108:111]
  ds_read_b64_tr_b16 a[80:81], v208 offset:20480
  v_mfma_f32_16x16x32_bf16 v[116:119], a[24:27], a[12:15], v[116:119]
  ds_read_b64_tr_b16 a[82:83], v208 offset:20992
  s_add_u32 m0, m0, 1024
  v_mfma_f32_16x16x32_bf16 v[124:127], a[24:27], a[16:19], v[124:127]
  ds_read_b64_tr_b16 a[84:85], v209 offset:20480
  buffer_load_dwordx4 v25, s[20:23], s61 offen lds
  v_mfma_f32_16x16x32_bf16 v[168:171], a[0:3], a[36:39], v[168:171]
  ds_read_b64_tr_b16 a[86:87], v209 offset:20992
  v_mfma_f32_16x16x32_bf16 v[176:179], a[4:7], a[36:39], v[176:179]
  v_mfma_f32_16x16x32_bf16 v[184:187], a[8:11], a[36:39], v[184:187]
  v_mfma_f32_16x16x32_bf16 v[192:195], a[12:15], a[36:39], v[192:195]
  s_add_u32 m0, m0, 1024
  v_mfma_f32_16x16x32_bf16 v[200:203], a[16:19], a[36:39], v[200:203]
  buffer_load_dwordx4 v26, s[20:23], s61 offen lds
  v_mfma_f32_16x16x32_bf16 v[172:175], a[0:3], a[40:43], v[172:175]
  v_mfma_f32_16x16x32_bf16 v[180:183], a[4:7], a[40:43], v[180:183]
  v_mfma_f32_16x16x32_bf16 v[188:191], a[8:11], a[40:43], v[188:191]
  v_mfma_f32_16x16x32_bf16 v[196:199], a[12:15], a[40:43], v[196:199]
  v_mfma_f32_16x16x32_bf16 v[204:207], a[16:19], a[40:43], v[204:207]
  s_waitcnt vmcnt(10) lgkmcnt(0)
  s_barrier
  v_mfma_f32_16x16x32_bf16 v[128:131], a[72:75], a[44:47], v[128:131]
  ds_read_b64_tr_b16 a[28:29], v37 offset:8192
  v_add_u32 v36, s63, v28
  v_mfma_f32_16x16x32_bf16 v[136:139], a[72:75], a[48:51], v[136:139]
  ds_read_b64_tr_b16 a[30:31], v37 offset:8704
  s_lshl_b32 s45, s44, 15
  s_add_u32 s44, s44, 1
  s_cmp_eq_u32 s44, s15
  s_cselect_b32 s44, 0, s44
  s_add_u32 m0, s96, 0
  s_add_u32 s57, s45, 0
  v_mfma_f32_16x16x32_bf16 v[144:147], a[72:75], a[52:55], v[144:147]
  ds_read_b128 a[0:3], v35 offset:0
  buffer_load_dwordx4 v87, s[24:27], s57 offen lds
  v_mfma_f32_16x16x32_bf16 v[152:155], a[72:75], a[56:59], v[152:155]
  ds_read_b128 a[4:7], v35 offset:2048
  v_mfma_f32_16x16x32_bf16 v[160:163], a[72:75], a[60:63], v[160:163]
  ds_read_b128 a[8:11], v35 offset:4096
  v_mfma_f32_16x16x32_bf16 v[132:135], a[76:79], a[44:47], v[132:135]
  ds_read_b64_tr_b16 a[32:33], v38 offset:8192
  s_add_u32 m0, s96, 1024
  s_add_u32 s57, s45, 8192
  v_mfma_f32_16x16x32_bf16 v[140:143], a[76:79], a[48:51], v[140:143]
  buffer_load_dwordx4 v87, s[24:27], s57 offen lds
  v_add_u32 v208, s63, v29
  v_mfma_f32_16x16x32_bf16 v[148:151], a[76:79], a[52:55], v[148:151]
  ds_read_b64_tr_b16 a[34:35], v38 offset:8704
  v_mfma_f32_16x16x32_bf16 v[156:159], a[76:79], a[56:59], v[156:159]
  ds_read_b128 a[12:15], v35 offset:6144
  v_mfma_f32_16x16x32_bf16 v[164:167], a[76:79], a[60:63], v[164:167]
  ds_read_b128 a[16:19], v35 offset:8192
  s_add_u32 m0, s96, 2048
  s_add_u32 s57, s45, 16384
  v_mfma_f32_16x16x32_bf16 v[96:99], a[64:67], a[48:51], v[96:99]
  ds_read_b64_tr_b16 a[20:21], v37 offset:0
  buffer_load_dwordx4 v87, s[24:27], s57 offen lds
  v_mfma_f32_16x16x32_bf16 v[104:107], a[64:67], a[52:55], v[104:107]
  ds_read_b64_tr_b16 a[22:23], v37 offset:512
  v_mfma_f32_16x16x32_bf16 v[112:115], a[64:67], a[56:59], v[112:115]
  ds_read_b64_tr_b16 a[24:25], v38 offset:0
  v_mfma_f32_16x16x32_bf16 v[120:123], a[64:67], a[60:63], v[120:123]
  v_add_u32 v209, s63, v30
  v_mfma_f32_16x16x32_bf16 v[100:103], a[68:71], a[48:51], v[100:103]
  ds_read_b64_tr_b16 a[26:27], v38 offset:512
  s_add_u32 m0, s96, 3072
  s_add_u32 s57, s45, 24576
  v_mfma_f32_16x16x32_bf16 v[108:111], a[68:71], a[52:55], v[108:111]
  ds_read_b64_tr_b16 a[36:37], v37 offset:16384
  buffer_load_dwordx4 v87, s[24:27], s57 offen lds
  v_mfma_f32_16x16x32_bf16 v[116:119], a[68:71], a[56:59], v[116:119]
  ds_read_b64_tr_b16 a[38:39], v37 offset:16896
  v_mfma_f32_16x16x32_bf16 v[124:127], a[68:71], a[60:63], v[124:127]
  ds_read_b64_tr_b16 a[40:41], v38 offset:16384
  v_mfma_f32_16x16x32_bf16 v[168:171], a[44:47], a[80:83], v[168:171]
  ds_read_b64_tr_b16 a[42:43], v38 offset:16896
  s_lshl_b32 s45, s44, 15
  s_add_u32 s44, s44, 1
  s_cmp_eq_u32 s44, s15
  s_cselect_b32 s44, 0, s44
  s_add_u32 m0, s96, 4096
  s_add_u32 s57, s45, 0
  v_mfma_f32_16x16x32_bf16 v[176:179], a[48:51], a[80:83], v[176:179]
  buffer_load_dwordx4 v87, s[24:27], s57 offen lds
  v_mfma_f32_16x16x32_bf16 v[184:187], a[52:55], a[80:83], v[184:187]
  v_mfma_f32_16x16x32_bf16 v[192:195], a[56:59], a[80:83], v[192:195]
  v_mfma_f32_16x16x32_bf16 v[200:203], a[60:63], a[80:83], v[200:203]
  s_add_u32 m0, s96, 5120
  s_add_u32 s57, s45, 8192
  v_mfma_f32_16x16x32_bf16 v[172:175], a[44:47], a[84:87], v[172:175]
  buffer_load_dwordx4 v87, s[24:27], s57 offen lds
  v_mfma_f32_16x16x32_bf16 v[180:183], a[48:51], a[84:87], v[180:183]
  v_mfma_f32_16x16x32_bf16 v[188:191], a[52:55], a[84:87], v[188:191]
  s_mov_b32 s65, s55
  s_mov_b32 s55, s54
  v_mfma_f32_16x16x32_bf16 v[196:199], a[56:59], a[84:87], v[196:199]
  s_mov_b32 s54, s63
  s_mov_b32 s63, s65
  v_mfma_f32_16x16x32_bf16 v[204:207], a[60:63], a[84:87], v[204:207]
  s_waitcnt lgkmcnt(0)
  v_mfma_f32_16x16x32_bf16 v[128:131], a[28:31], a[0:3], v[128:131]
  ds_read_b64_tr_b16 a[72:73], v208 offset:12288
  v_add_u32 v35, s63, v27
  v_mfma_f32_16x16x32_bf16 v[136:139], a[28:31], a[4:7], v[136:139]
  ds_read_b64_tr_b16 a[74:75], v208 offset:12800
  s_add_u32 m0, s96, 6144
  s_add_u32 s57, s45, 16384
  v_mfma_f32_16x16x32_bf16 v[144:147], a[28:31], a[8:11], v[144:147]
  ds_read_b128 a[44:47], v36 offset:0
  buffer_load_dwordx4 v87, s[24:27], s57 offen lds
  v_mfma_f32_16x16x32_bf16 v[152:155], a[28:31], a[12:15], v[152:155]
  ds_read_b128 a[48:51], v36 offset:2048
  v_mfma_f32_16x16x32_bf16 v[160:163], a[28:31], a[16:19], v[160:163]
  ds_read_b128 a[52:55], v36 offset:4096
  v_mfma_f32_16x16x32_bf16 v[132:135], a[32:35], a[0:3], v[132:135]
  ds_read_b64_tr_b16 a[76:77], v209 offset:12288
  s_add_u32 m0, s96, 7168
  s_add_u32 s57, s45, 24576
  v_mfma_f32_16x16x32_bf16 v[140:143], a[32:35], a[4:7], v[140:143]
  buffer_load_dwordx4 v87, s[24:27], s57 offen lds
  v_add_u32 v37, s63, v29
  v_mfma_f32_16x16x32_bf16 v[148:151], a[32:35], a[8:11], v[148:151]
  ds_read_b64_tr_b16 a[78:79], v209 offset:12800
  v_mfma_f32_16x16x32_bf16 v[156:159], a[32:35], a[12:15], v[156:159]
  ds_read_b128 a[56:59], v36 offset:6144
  v_mfma_f32_16x16x32_bf16 v[164:167], a[32:35], a[16:19], v[164:167]
  ds_read_b128 a[60:63], v36 offset:8192
  s_lshl_b32 s45, s44, 15
  s_add_u32 s44, s44, 1
  s_cmp_eq_u32 s44, s15
  s_cselect_b32 s44, 0, s44
  s_add_u32 m0, s96, 8192
  s_add_u32 s57, s45, 0
  v_mfma_f32_16x16x32_bf16 v[96:99], a[20:23], a[4:7], v[96:99]
  ds_read_b64_tr_b16 a[64:65], v208 offset:4096
  buffer_load_dwordx4 v87, s[24:27], s57 offen lds
  v_mfma_f32_16x16x32_bf16 v[104:107], a[20:23], a[8:11], v[104:107]
  ds_read_b64_tr_b16 a[66:67], v208 offset:4608
  v_mfma_f32_16x16x32_bf16 v[112:115], a[20:23], a[12:15], v[112:115]
  ds_read_b64_tr_b16 a[68:69], v209 offset:4096
  v_add_u32 v38, s63, v30
  v_mfma_f32_16x16x32_bf16 v[120:123], a[20:23], a[16:19], v[120:123]
  v_mfma_f32_16x16x32_bf16 v[100:103], a[24:27], a[4:7], v[100:103]
  ds_read_b64_tr_b16 a[70:71], v209 offset:4608
  s_add_u32 m0, s96, 9216
  s_add_u32 s57, s45, 8192
  v_mfma_f32_16x16x32_bf16 v[108:111], a[24:27], a[8:11], v[108:111]
  ds_read_b64_tr_b16 a[80:81], v208 offset:20480
  buffer_load_dwordx4 v87, s[24:27], s57 offen lds
  v_mfma_f32_16x16x32_bf16 v[116:119], a[24:27], a[12:15], v[116:119]
  ds_read_b64_tr_b16 a[82:83], v208 offset:20992
  v_mfma_f32_16x16x32_bf16 v[124:127], a[24:27], a[16:19], v[124:127]
  ds_read_b64_tr_b16 a[84:85], v209 offset:20480
  v_mfma_f32_16x16x32_bf16 v[168:171], a[0:3], a[36:39], v[168:171]
  ds_read_b64_tr_b16 a[86:87], v209 offset:20992
  s_add_u32 m0, s96, 10240
  s_add_u32 s57, s45, 16384
  v_mfma_f32_16x16x32_bf16 v[176:179], a[4:7], a[36:39], v[176:179]
  buffer_load_dwordx4 v87, s[24:27], s57 offen lds
  v_mfma_f32_16x16x32_bf16 v[184:187], a[8:11], a[36:39], v[184:187]
  v_mfma_f32_16x16x32_bf16 v[192:195], a[12:15], a[36:39], v[192:195]
  v_mfma_f32_16x16x32_bf16 v[200:203], a[16:19], a[36:39], v[200:203]
  s_add_u32 m0, s96, 11264
  s_add_u32 s57, s45, 24576
  v_mfma_f32_16x16x32_bf16 v[172:175], a[0:3], a[40:43], v[172:175]
  buffer_load_dwordx4 v87, s[24:27], s57 offen lds
  v_mfma_f32_16x16x32_bf16 v[180:183], a[4:7], a[40:43], v[180:183]
  v_mfma_f32_16x16x32_bf16 v[188:191], a[8:11], a[40:43], v[188:191]
  v_mfma_f32_16x16x32_bf16 v[196:199], a[12:15], a[40:43], v[196:199]
  v_mfma_f32_16x16x32_bf16 v[204:207], a[16:19], a[40:43], v[204:207]
  s_waitcnt vmcnt(12) lgkmcnt(0)
  s_barrier
  v_mfma_f32_16x16x32_bf16 v[128:131], a[72:75], a[44:47], v[128:131]
  ds_read_b64_tr_b16 a[28:29], v37 offset:8192
  v_add_u32 v36, s63, v28
  v_mfma_f32_16x16x32_bf16 v[136:139], a[72:75], a[48:51], v[136:139]
  ds_read_b64_tr_b16 a[30:31], v37 offset:8704
  s_lshl_b32 s45, s44, 15
  s_add_u32 s44, s44, 1
  s_cmp_eq_u32 s44, s15
  s_cselect_b32 s44, 0, s44
  s_add_u32 m0, s96, 12288
  s_add_u32 s57, s45, 0
  v_mfma_f32_16x16x32_bf16 v[144:147], a[72:75], a[52:55], v[144:147]
  ds_read_b128 a[0:3], v35 offset:0
  buffer_load_dwordx4 v87, s[24:27], s57 offen lds
  v_mfma_f32_16x16x32_bf16 v[152:155], a[72:75], a[56:59], v[152:155]
  ds_read_b128 a[4:7], v35 offset:2048
  v_mfma_f32_16x16x32_bf16 v[160:163], a[72:75], a[60:63], v[160:163]
  ds_read_b128 a[8:11], v35 offset:4096
  v_mfma_f32_16x16x32_bf16 v[132:135], a[76:79], a[44:47], v[132:135]
  ds_read_b64_tr_b16 a[32:33], v38 offset:8192
  s_add_u32 m0, s96, 13312
  s_add_u32 s57, s45, 8192
  v_mfma_f32_16x16x32_bf16 v[140:143], a[76:79], a[48:51], v[140:143]
  buffer_load_dwordx4 v87, s[24:27], s57 offen lds
  v_add_u32 v208, s63, v29
  v_mfma_f32_16x16x32_bf16 v[148:151], a[76:79], a[52:55], v[148:151]
  ds_read_b64_tr_b16 a[34:35], v38 offset:8704
  v_mfma_f32_16x16x32_bf16 v[156:159], a[76:79], a[56:59], v[156:159]
  ds_read_b128 a[12:15], v35 offset:6144
  v_mfma_f32_16x16x32_bf16 v[164:167], a[76:79], a[60:63], v[164:167]
  ds_read_b128 a[16:19], v35 offset:8192
  s_add_u32 m0, s96, 14336
  s_add_u32 s57, s45, 16384
  v_mfma_f32_16x16x32_bf16 v[96:99], a[64:67], a[48:51], v[96:99]
  ds_read_b64_tr_b16 a[20:21], v37 offset:0
  buffer_load_dwordx4 v87, s[24:27], s57 offen lds
  v_mfma_f32_16x16x32_bf16 v[104:107], a[64:67], a[52:55], v[104:107]
  ds_read_b64_tr_b16 a[22:23], v37 offset:512
  v_mfma_f32_16x16x32_bf16 v[112:115], a[64:67], a[56:59], v[112:115]
  ds_read_b64_tr_b16 a[24:25], v38 offset:0
  v_mfma_f32_16x16x32_bf16 v[120:123], a[64:67], a[60:63], v[120:123]
  v_add_u32 v209, s63, v30
  v_mfma_f32_16x16x32_bf16 v[100:103], a[68:71], a[48:51], v[100:103]
  ds_read_b64_tr_b16 a[26:27], v38 offset:512
  s_add_u32 m0, s96, 15360
  s_add_u32 s57, s45, 24576
  v_mfma_f32_16x16x32_bf16 v[108:111], a[68:71], a[52:55], v[108:111]
  ds_read_b64_tr_b16 a[36:37], v37 offset:16384
  buffer_load_dwordx4 v87, s[24:27], s57 offen lds
  v_mfma_f32_16x16x32_bf16 v[116:119], a[68:71], a[56:59], v[116:119]
  ds_read_b64_tr_b16 a[38:39], v37 offset:16896
  v_mfma_f32_16x16x32_bf16 v[124:127], a[68:71], a[60:63], v[124:127]
  ds_read_b64_tr_b16 a[40:41], v38 offset:16384
  v_mfma_f32_16x16x32_bf16 v[168:171], a[44:47], a[80:83], v[168:171]
  ds_read_b64_tr_b16 a[42:43], v38 offset:16896
  s_lshl_b32 s45, s44, 15
  s_add_u32 s44, s44, 1
  s_cmp_eq_u32 s44, s15
  s_cselect_b32 s44, 0, s44
  s_add_u32 m0, s97, 0
  s_add_u32 s57, s45, 0
  v_mfma_f32_16x16x32_bf16 v[176:179], a[48:51], a[80:83], v[176:179]
  buffer_load_dwordx4 v87, s[24:27], s57 offen lds
  v_mfma_f32_16x16x32_bf16 v[184:187], a[52:55], a[80:83], v[184:187]
  v_mfma_f32_16x16x32_bf16 v[192:195], a[56:59], a[80:83], v[192:195]
  v_mfma_f32_16x16x32_bf16 v[200:203], a[60:63], a[80:83], v[200:203]
  s_add_u32 m0, s97, 1024
  s_add_u32 s57, s45, 8192
  v_mfma_f32_16x16x32_bf16 v[172:175], a[44:47], a[84:87], v[172:175]
  buffer_load_dwordx4 v87, s[24:27], s57 offen lds
  v_mfma_f32_16x16x32_bf16 v[180:183], a[48:51], a[84:87], v[180:183]
  v_mfma_f32_16x16x32_bf16 v[188:191], a[52:55], a[84:87], v[188:191]
  s_mov_b32 s65, s55
  s_mov_b32 s55, s54
  v_mfma_f32_16x16x32_bf16 v[196:199], a[56:59], a[84:87], v[196:199]
  s_mov_b32 s54, s63
  s_mov_b32 s63, s65
  v_mfma_f32_16x16x32_bf16 v[204:207], a[60:63], a[84:87], v[204:207]
  s_waitcnt lgkmcnt(0)
  v_mfma_f32_16x16x32_bf16 v[128:131], a[28:31], a[0:3], v[128:131]
  ds_read_b64_tr_b16 a[72:73], v208 offset:12288
  v_mfma_f32_16x16x32_bf16 v[136:139], a[28:31], a[4:7], v[136:139]
  ds_read_b64_tr_b16 a[74:75], v208 offset:12800
  s_add_u32 m0, s97, 2048
  s_add_u32 s57, s45, 16384
  v_mfma_f32_16x16x32_bf16 v[144:147], a[28:31], a[8:11], v[144:147]
  ds_read_b128 a[44:47], v36 offset:0
  buffer_load_dwordx4 v87, s[24:27], s57 offen lds
  v_mfma_f32_16x16x32_bf16 v[152:155], a[28:31], a[12:15], v[152:155]
  ds_read_b128 a[48:51], v36 offset:2048
  v_mfma_f32_16x16x32_bf16 v[160:163], a[28:31], a[16:19], v[160:163]
  ds_read_b128 a[52:55], v36 offset:4096
  v_mfma_f32_16x16x32_bf16 v[132:135], a[32:35], a[0:3], v[132:135]
  ds_read_b64_tr_b16 a[76:77], v209 offset:12288
  s_add_u32 m0, s97, 3072
  s_add_u32 s57, s45, 24576
  v_mfma_f32_16x16x32_bf16 v[140:143], a[32:35], a[4:7], v[140:143]
  buffer_load_dwordx4 v87, s[24:27], s57 offen lds
  v_mfma_f32_16x16x32_bf16 v[148:151], a[32:35], a[8:11], v[148:151]
  ds_read_b64_tr_b16 a[78:79], v209 offset:12800
  v_mfma_f32_16x16x32_bf16 v[156:159], a[32:35], a[12:15], v[156:159]
  ds_read_b128 a[56:59], v36 offset:6144
  v_mfma_f32_16x16x32_bf16 v[164:167], a[32:35], a[16:19], v[164:167]
  ds_read_b128 a[60:63], v36 offset:8192
  s_lshl_b32 s45, s44, 15
  s_add_u32 s44, s44, 1
  s_cmp_eq_u32 s44, s15
  s_cselect_b32 s44, 0, s44
  s_add_u32 m0, s97, 4096
  s_add_u32 s57, s45, 0
  v_mfma_f32_16x16x32_bf16 v[96:99], a[20:23], a[4:7], v[96:99]
  ds_read_b64_tr_b16 a[64:65], v208 offset:4096
  buffer_load_dwordx4 v87, s[24:27], s57 offen lds
  v_mfma_f32_16x16x32_bf16 v[104:107], a[20:23], a[8:11], v[104:107]
  ds_read_b64_tr_b16 a[66:67], v208 offset:4608
  v_mfma_f32_16x16x32_bf16 v[112:115], a[20:23], a[12:15], v[112:115]
  ds_read_b64_tr_b16 a[68:69], v209 offset:4096
  v_mfma_f32_16x16x32_bf16 v[120:123], a[20:23], a[16:19], v[120:123]
  v_mfma_f32_16x16x32_bf16 v[100:103], a[24:27], a[4:7], v[100:103]
  ds_read_b64_tr_b16 a[70:71], v209 offset:4608
  s_add_u32 m0, s97, 5120
  s_add_u32 s57, s45, 8192
  v_mfma_f32_16x16x32_bf16 v[108:111], a[24:27], a[8:11], v[108:111]
  ds_read_b64_tr_b16 a[80:81], v208 offset:20480
  buffer_load_dwordx4 v87, s[24:27], s57 offen lds
  v_mfma_f32_16x16x32_bf16 v[116:119], a[24:27], a[12:15], v[116:119]
  ds_read_b64_tr_b16 a[82:83], v208 offset:20992
  v_mfma_f32_16x16x32_bf16 v[124:127], a[24:27], a[16:19], v[124:127]
  ds_read_b64_tr_b16 a[84:85], v209 offset:20480
  v_mfma_f32_16x16x32_bf16 v[168:171], a[0:3], a[36:39], v[168:171]
  ds_read_b64_tr_b16 a[86:87], v209 offset:20992
  s_add_u32 m0, s97, 6144
  s_add_u32 s57, s45, 16384
  v_mfma_f32_16x16x32_bf16 v[176:179], a[4:7], a[36:39], v[176:179]
  buffer_load_dwordx4 v87, s[24:27], s57 offen lds
  v_mfma_f32_16x16x32_bf16 v[184:187], a[8:11], a[36:39], v[184:187]
  v_mfma_f32_16x16x32_bf16 v[192:195], a[12:15], a[36:39], v[192:195]
  v_mfma_f32_16x16x32_bf16 v[200:203], a[16:19], a[36:39], v[200:203]
  s_add_u32 m0, s97, 7168
  s_add_u32 s57, s45, 24576
  v_mfma_f32_16x16x32_bf16 v[172:175], a[0:3], a[40:43], v[172:175]
  buffer_load_dwordx4 v87, s[24:27], s57 offen lds
  v_mfma_f32_16x16x32_bf16 v[180:183], a[4:7], a[40:43], v[180:183]
  v_mfma_f32_16x16x32_bf16 v[188:191], a[8:11], a[40:43], v[188:191]
  v_mfma_f32_16x16x32_bf16 v[196:199], a[12:15], a[40:43], v[196:199]
  v_mfma_f32_16x16x32_bf16 v[204:207], a[16:19], a[40:43], v[204:207]
  s_waitcnt lgkmcnt(0)
  s_barrier
  v_mfma_f32_16x16x32_bf16 v[128:131], a[72:75], a[44:47], v[128:131]
  v_mfma_f32_16x16x32_bf16 v[136:139], a[72:75], a[48:51], v[136:139]
  s_lshl_b32 s45, s44, 15
  s_add_u32 s44, s44, 1
  s_cmp_eq_u32 s44, s15
  s_cselect_b32 s44, 0, s44
  s_add_u32 m0, s98, 0
  s_add_u32 s57, s45, 0
  v_mfma_f32_16x16x32_bf16 v[144:147], a[72:75], a[52:55], v[144:147]
  buffer_load_dwordx4 v87, s[24:27], s57 offen lds
  v_mfma_f32_16x16x32_bf16 v[152:155], a[72:75], a[56:59], v[152:155]
  v_mfma_f32_16x16x32_bf16 v[160:163], a[72:75], a[60:63], v[160:163]
  s_add_u32 m0, s98, 1024
  s_add_u32 s57, s45, 8192
  v_mfma_f32_16x16x32_bf16 v[132:135], a[76:79], a[44:47], v[132:135]
  buffer_load_dwordx4 v87, s[24:27], s57 offen lds
  v_mfma_f32_16x16x32_bf16 v[140:143], a[76:79], a[48:51], v[140:143]
  v_mfma_f32_16x16x32_bf16 v[148:151], a[76:79], a[52:55], v[148:151]
  s_add_u32 m0, s98, 2048
  s_add_u32 s57, s45, 16384
  v_mfma_f32_16x16x32_bf16 v[156:159], a[76:79], a[56:59], v[156:159]
  buffer_load_dwordx4 v87, s[24:27], s57 offen lds
  v_mfma_f32_16x16x32_bf16 v[164:167], a[76:79], a[60:63], v[164:167]
  v_mfma_f32_16x16x32_bf16 v[96:99], a[64:67], a[48:51], v[96:99]
  s_add_u32 m0, s98, 3072
  s_add_u32 s57, s45, 24576
  v_mfma_f32_16x16x32_bf16 v[104:107], a[64:67], a[52:55], v[104:107]
  buffer_load_dwordx4 v87, s[24:27], s57 offen lds
  v_mfma_f32_16x16x32_bf16 v[112:115], a[64:67], a[56:59], v[112:115]
  v_mfma_f32_16x16x32_bf16 v[120:123], a[64:67], a[60:63], v[120:123]
  v_mfma_f32_16x16x32_bf16 v[100:103], a[68:71], a[48:51], v[100:103]
  s_lshl_b32 s45, s44, 15
  s_add_u32 s44, s44, 1
  s_cmp_eq_u32 s44, s15
  s_cselect_b32 s44, 0, s44
  s_add_u32 m0, s99, 0
  s_add_u32 s57, s45, 0
  v_mfma_f32_16x16x32_bf16 v[108:111], a[68:71], a[52:55], v[108:111]
  buffer_load_dwordx4 v87, s[24:27], s57 offen lds
  v_mfma_f32_16x16x32_bf16 v[116:119], a[68:71], a[56:59], v[116:119]
  v_mfma_f32_16x16x32_bf16 v[124:127], a[68:71], a[60:63], v[124:127]
  s_add_u32 m0, s99, 1024
  s_add_u32 s57, s45, 8192
  v_mfma_f32_16x16x32_bf16 v[168:171], a[44:47], a[80:83], v[168:171]
  buffer_load_dwordx4 v87, s[24:27], s57 offen lds
  v_mfma_f32_16x16x32_bf16 v[176:179], a[48:51], a[80:83], v[176:179]
  v_mfma_f32_16x16x32_bf16 v[184:187], a[52:55], a[80:83], v[184:187]
  s_add_u32 m0, s99, 2048
  s_add_u32 s57, s45, 16384
  v_mfma_f32_16x16x32_bf16 v[192:195], a[56:59], a[80:83], v[192:195]
  buffer_load_dwordx4 v87, s[24:27], s57 offen lds
  v_mfma_f32_16x16x32_bf16 v[200:203], a[60:63], a[80:83], v[200:203]
  v_mfma_f32_16x16x32_bf16 v[172:175], a[44:47], a[84:87], v[172:175]
  s_add_u32 m0, s99, 3072
  s_add_u32 s57, s45, 24576
  v_mfma_f32_16x16x32_bf16 v[180:183], a[48:51], a[84:87], v[180:183]
  buffer_load_dwordx4 v87, s[24:27], s57 offen lds
  v_mfma_f32_16x16x32_bf16 v[188:191], a[52:55], a[84:87], v[188:191]
  v_mfma_f32_16x16x32_bf16 v[196:199], a[56:59], a[84:87], v[196:199]
  v_mfma_f32_16x16x32_bf16 v[204:207], a[60:63], a[84:87], v[204:207]
  global_load_dword v64, v43, s[50:51] sc1
  s_nop 7
  v_cvt_pk_bf16_f32 v208, v128, v129
  s_lshl_b32 s45, s44, 15
  s_add_u32 s44, s44, 1
  s_cmp_eq_u32 s44, s15
  s_cselect_b32 s44, 0, s44
  s_add_u32 m0, s100, 0
  s_add_u32 s57, s45, 0
  v_cvt_pk_bf16_f32 v209, v130, v131
  v_cvt_pk_bf16_f32 v218, v132, v133
  buffer_load_dwordx4 v87, s[24:27], s57 offen lds
  v_cvt_pk_bf16_f32 v219, v134, v135
  v_cvt_pk_bf16_f32 v210, v136, v137
  v_cvt_pk_bf16_f32 v211, v138, v139
  v_cvt_pk_bf16_f32 v220, v140, v141
  v_cvt_pk_bf16_f32 v221, v142, v143
  v_cvt_pk_bf16_f32 v212, v144, v145
  v_cvt_pk_bf16_f32 v213, v146, v147
  s_add_u32 m0, s100, 1024
  s_add_u32 s57, s45, 8192
  v_cvt_pk_bf16_f32 v222, v148, v149
  v_cvt_pk_bf16_f32 v223, v150, v151
  buffer_load_dwordx4 v87, s[24:27], s57 offen lds
  v_cvt_pk_bf16_f32 v214, v152, v153
  v_cvt_pk_bf16_f32 v215, v154, v155
  v_cvt_pk_bf16_f32 v224, v156, v157
  v_cvt_pk_bf16_f32 v225, v158, v159
  v_cvt_pk_bf16_f32 v216, v160, v161
  v_cvt_pk_bf16_f32 v217, v162, v163
  v_cvt_pk_bf16_f32 v226, v164, v165
  v_cvt_pk_bf16_f32 v227, v166, v167
  s_add_u32 m0, s100, 2048
  s_add_u32 s57, s45, 16384
  v_cvt_pk_bf16_f32 v16, v96, v97
  v_cvt_pk_bf16_f32 v17, v98, v99
  buffer_load_dwordx4 v87, s[24:27], s57 offen lds
  v_cvt_pk_bf16_f32 v18, v100, v101
  v_cvt_pk_bf16_f32 v19, v102, v103
  v_cvt_pk_bf16_f32 v20, v104, v105
  v_cvt_pk_bf16_f32 v21, v106, v107
  v_cvt_pk_bf16_f32 v22, v108, v109
  v_cvt_pk_bf16_f32 v23, v110, v111
  v_cvt_pk_bf16_f32 v24, v112, v113
  s_add_u32 m0, s100, 3072
  s_add_u32 s57, s45, 24576
  v_cvt_pk_bf16_f32 v25, v114, v115
  v_cvt_pk_bf16_f32 v26, v116, v117
  buffer_load_dwordx4 v87, s[24:27], s57 offen lds
  v_cvt_pk_bf16_f32 v27, v118, v119
  v_cvt_pk_bf16_f32 v28, v120, v121
  v_cvt_pk_bf16_f32 v29, v122, v123
  v_cvt_pk_bf16_f32 v30, v124, v125
  v_cvt_pk_bf16_f32 v31, v126, v127
  s_nop 1
  v_mfma_f32_16x16x16_bf16 v[96:99], v[208:209], v[16:17], 0
  v_cvt_pk_bf16_f32 v228, v168, v169
  v_mfma_f32_16x16x16_bf16 v[100:103], v[210:211], v[16:17], 0
  v_cvt_pk_bf16_f32 v229, v170, v171
  v_mfma_f32_16x16x16_bf16 v[104:107], v[218:219], v[18:19], 0
  v_cvt_pk_bf16_f32 v238, v172, v173
  v_mfma_f32_16x16x16_bf16 v[108:111], v[220:221], v[18:19], 0
  v_cvt_pk_bf16_f32 v239, v174, v175
  v_cvt_pk_bf16_f32 v230, v176, v177
  v_mfma_f32_16x16x16_bf16 v[112:115], v[210:211], v[20:21], 0
  v_cvt_pk_bf16_f32 v231, v178, v179
  v_mfma_f32_16x16x16_bf16 v[116:119], v[212:213], v[20:21], 0
  v_cvt_pk_bf16_f32 v240, v180, v181
  v_mfma_f32_16x16x16_bf16 v[120:123], v[220:221], v[22:23], 0
  v_cvt_pk_bf16_f32 v241, v182, v183
  v_mfma_f32_16x16x16_bf16 v[124:127], v[222:223], v[22:23], 0
  v_cvt_pk_bf16_f32 v232, v184, v185
  v_cvt_pk_bf16_f32 v233, v186, v187
  v_mfma_f32_16x16x16_bf16 v[128:131], v[212:213], v[24:25], 0
  v_cvt_pk_bf16_f32 v242, v188, v189
  v_mfma_f32_16x16x16_bf16 v[132:135], v[214:215], v[24:25], 0
  v_cvt_pk_bf16_f32 v243, v190, v191
  v_mfma_f32_16x16x16_bf16 v[136:139], v[222:223], v[26:27], 0
  v_cvt_pk_bf16_f32 v234, v192, v193
  v_mfma_f32_16x16x16_bf16 v[140:143], v[224:225], v[26:27], 0
  v_cvt_pk_bf16_f32 v235, v194, v195
  v_cvt_pk_bf16_f32 v244, v196, v197
  v_mfma_f32_16x16x16_bf16 v[144:147], v[214:215], v[28:29], 0
  v_cvt_pk_bf16_f32 v245, v198, v199
  v_mfma_f32_16x16x16_bf16 v[148:151], v[216:217], v[28:29], 0
  v_cvt_pk_bf16_f32 v236, v200, v201
  v_mfma_f32_16x16x16_bf16 v[152:155], v[224:225], v[30:31], 0
  v_cvt_pk_bf16_f32 v237, v202, v203
  v_mfma_f32_16x16x16_bf16 v[156:159], v[226:227], v[30:31], 0
  v_cvt_pk_bf16_f32 v246, v204, v205
  v_cvt_pk_bf16_f32 v247, v206, v207
  s_nop 7
  v_cndmask_b32 v160, v96, v97, s[46:47]
  v_cndmask_b32 v161, v98, v99, s[46:47]
  v_cndmask_b32 v162, v100, v101, s[46:47]
  v_cndmask_b32 v163, v102, v103, s[46:47]
  v_cndmask_b32 v164, v104, v105, s[46:47]
  v_cndmask_b32 v165, v106, v107, s[46:47]
  v_cndmask_b32 v166, v108, v109, s[46:47]
  v_cndmask_b32 v167, v110, v111, s[46:47]
  v_cndmask_b32 v168, v112, v113, s[46:47]
  v_cndmask_b32 v169, v114, v115, s[46:47]
  v_cndmask_b32 v170, v116, v117, s[46:47]
  v_cndmask_b32 v171, v118, v119, s[46:47]
  v_cndmask_b32 v172, v120, v121, s[46:47]
  v_cndmask_b32 v173, v122, v123, s[46:47]
  v_cndmask_b32 v174, v124, v125, s[46:47]
  v_cndmask_b32 v175, v126, v127, s[46:47]
  v_cndmask_b32 v176, v128, v129, s[46:47]
  v_cndmask_b32 v177, v130, v131, s[46:47]
  v_cndmask_b32 v178, v132, v133, s[46:47]
  v_cndmask_b32 v179, v134, v135, s[46:47]
  v_cndmask_b32 v180, v136, v137, s[46:47]
  v_cndmask_b32 v181, v138, v139, s[46:47]
  v_cndmask_b32 v182, v140, v141, s[46:47]
  v_cndmask_b32 v183, v142, v143, s[46:47]
  v_cndmask_b32 v184, v144, v145, s[46:47]
  v_cndmask_b32 v185, v146, v147, s[46:47]
  v_cndmask_b32 v186, v148, v149, s[46:47]
  v_cndmask_b32 v187, v150, v151, s[46:47]
  v_cndmask_b32 v188, v152, v153, s[46:47]
  v_cndmask_b32 v189, v154, v155, s[46:47]
  v_cndmask_b32 v190, v156, v157, s[46:47]
  v_cndmask_b32 v191, v158, v159, s[46:47]
  v_pk_fma_f32 v[160:161], v[160:161], s[0:1], v[74:75] op_sel_hi:[1,0,1]
  v_pk_fma_f32 v[162:163], v[162:163], s[0:1], v[70:71] op_sel_hi:[1,0,1]
  v_pk_fma_f32 v[164:165], v[164:165], s[0:1], v[74:75] op_sel_hi:[1,0,1]
  v_pk_fma_f32 v[166:167], v[166:167], s[0:1], v[70:71] op_sel_hi:[1,0,1]
  v_pk_fma_f32 v[168:169], v[168:169], s[0:1], v[72:73] op_sel_hi:[1,0,1]
  v_pk_fma_f32 v[170:171], v[170:171], s[0:1], v[70:71] op_sel_hi:[1,0,1]
  v_pk_fma_f32 v[172:173], v[172:173], s[0:1], v[72:73] op_sel_hi:[1,0,1]
  v_pk_fma_f32 v[174:175], v[174:175], s[0:1], v[70:71] op_sel_hi:[1,0,1]
  v_pk_fma_f32 v[176:177], v[176:177], s[0:1], v[72:73] op_sel_hi:[1,0,1]
  v_pk_fma_f32 v[178:179], v[178:179], s[0:1], v[70:71] op_sel_hi:[1,0,1]
  v_pk_fma_f32 v[180:181], v[180:181], s[0:1], v[72:73] op_sel_hi:[1,0,1]
  v_pk_fma_f32 v[182:183], v[182:183], s[0:1], v[70:71] op_sel_hi:[1,0,1]
  v_pk_fma_f32 v[184:185], v[184:185], s[0:1], v[72:73] op_sel_hi:[1,0,1]
  v_pk_fma_f32 v[186:187], v[186:187], s[0:1], v[70:71] op_sel_hi:[1,0,1]
  v_pk_fma_f32 v[188:189], v[188:189], s[0:1], v[72:73] op_sel_hi:[1,0,1]
  v_pk_fma_f32 v[190:191], v[190:191], s[0:1], v[70:71] op_sel_hi:[1,0,1]
  v_max3_f32 v4, v160, v161, v162
  v_max3_f32 v5, v164, v165, v166
  v_max3_f32 v6, v168, v169, v170
  v_max3_f32 v7, v172, v173, v174
  v_max3_f32 v8, v176, v177, v178
  v_max3_f32 v9, v180, v181, v182
  v_max3_f32 v10, v184, v185, v186
  v_max3_f32 v11, v188, v189, v190
  v_max_f32 v4, v4, v163
  v_max_f32 v5, v5, v167
  v_max_f32 v6, v6, v171
  v_max_f32 v7, v7, v175
  v_max_f32 v8, v8, v179
  v_max_f32 v9, v9, v183
  v_max_f32 v10, v10, v187
  v_max_f32 v11, v11, v191
  s_nop 0
  v_permlane32_swap_b32 v4, v5
  v_permlane32_swap_b32 v6, v7
  v_permlane32_swap_b32 v8, v9
  v_permlane32_swap_b32 v10, v11
  v_max_f32 v4, v4, v5
  v_max_f32 v6, v6, v7
  v_max_f32 v8, v8, v9
  v_max_f32 v10, v10, v11
  s_nop 0
  v_permlane16_swap_b32 v4, v6
  v_permlane16_swap_b32 v8, v10
  s_nop 0
  v_max_f32 v4, v4, v6
  v_max_f32 v8, v8, v10
  v_mov_b32 v5, v4
  v_mov_b32 v9, v8
  s_nop 0
  v_permlane32_swap_b32 v4, v5
  v_permlane32_swap_b32 v8, v9
  s_nop 0
  v_mov_b32 v6, v4
  v_mov_b32 v7, v5
  v_mov_b32 v10, v8
  v_mov_b32 v11, v9
  s_nop 0
  v_permlane16_swap_b32 v4, v6
  v_permlane16_swap_b32 v5, v7
  v_permlane16_swap_b32 v8, v10
  v_permlane16_swap_b32 v9, v11
  s_nop 0
  v_pk_add_f32 v[160:161], v[160:161], v[4:5] op_sel:[0,0] op_sel_hi:[1,0] neg_lo:[0,1] neg_hi:[0,1]
  v_pk_add_f32 v[162:163], v[162:163], v[4:5] op_sel:[0,0] op_sel_hi:[1,0] neg_lo:[0,1] neg_hi:[0,1]
  v_pk_add_f32 v[164:165], v[164:165], v[4:5] op_sel:[0,1] op_sel_hi:[1,1] neg_lo:[0,1] neg_hi:[0,1]
  v_pk_add_f32 v[166:167], v[166:167], v[4:5] op_sel:[0,1] op_sel_hi:[1,1] neg_lo:[0,1] neg_hi:[0,1]
  v_pk_add_f32 v[168:169], v[168:169], v[6:7] op_sel:[0,0] op_sel_hi:[1,0] neg_lo:[0,1] neg_hi:[0,1]
  v_pk_add_f32 v[170:171], v[170:171], v[6:7] op_sel:[0,0] op_sel_hi:[1,0] neg_lo:[0,1] neg_hi:[0,1]
  v_pk_add_f32 v[172:173], v[172:173], v[6:7] op_sel:[0,1] op_sel_hi:[1,1] neg_lo:[0,1] neg_hi:[0,1]
  v_pk_add_f32 v[174:175], v[174:175], v[6:7] op_sel:[0,1] op_sel_hi:[1,1] neg_lo:[0,1] neg_hi:[0,1]
  v_pk_add_f32 v[176:177], v[176:177], v[8:9] op_sel:[0,0] op_sel_hi:[1,0] neg_lo:[0,1] neg_hi:[0,1]
  v_pk_add_f32 v[178:179], v[178:179], v[8:9] op_sel:[0,0] op_sel_hi:[1,0] neg_lo:[0,1] neg_hi:[0,1]
  v_pk_add_f32 v[180:181], v[180:181], v[8:9] op_sel:[0,1] op_sel_hi:[1,1] neg_lo:[0,1] neg_hi:[0,1]
  v_pk_add_f32 v[182:183], v[182:183], v[8:9] op_sel:[0,1] op_sel_hi:[1,1] neg_lo:[0,1] neg_hi:[0,1]
  v_pk_add_f32 v[184:185], v[184:185], v[10:11] op_sel:[0,0] op_sel_hi:[1,0] neg_lo:[0,1] neg_hi:[0,1]
  v_pk_add_f32 v[186:187], v[186:187], v[10:11] op_sel:[0,0] op_sel_hi:[1,0] neg_lo:[0,1] neg_hi:[0,1]
  v_pk_add_f32 v[188:189], v[188:189], v[10:11] op_sel:[0,1] op_sel_hi:[1,1] neg_lo:[0,1] neg_hi:[0,1]
  v_pk_add_f32 v[190:191], v[190:191], v[10:11] op_sel:[0,1] op_sel_hi:[1,1] neg_lo:[0,1] neg_hi:[0,1]
  v_exp_f32 v160, v160
  v_exp_f32 v161, v161
  v_exp_f32 v162, v162
  v_exp_f32 v163, v163
  v_exp_f32 v164, v164
  v_exp_f32 v165, v165
  v_exp_f32 v166, v166
  v_exp_f32 v167, v167
  v_cvt_pk_bf16_f32 v12, v160, v161
  v_cvt_pk_bf16_f32 v13, v162, v163
  v_perm_b32 v96, v12, v12, v76
  v_perm_b32 v97, v12, v12, v77
  v_perm_b32 v98, v13, v13, v76
  v_perm_b32 v99, v13, v13, v77
  v_exp_f32 v168, v168
  v_exp_f32 v169, v169
  v_exp_f32 v170, v170
  v_exp_f32 v171, v171
  v_cvt_pk_bf16_f32 v12, v164, v165
  v_cvt_pk_bf16_f32 v13, v166, v167
  v_perm_b32 v100, v12, v12, v76
  v_perm_b32 v101, v12, v12, v77
  v_perm_b32 v102, v13, v13, v76
  v_perm_b32 v103, v13, v13, v77
  v_exp_f32 v172, v172
  v_exp_f32 v173, v173
  v_exp_f32 v174, v174
  v_exp_f32 v175, v175
  v_cvt_pk_bf16_f32 v12, v168, v169
  v_cvt_pk_bf16_f32 v13, v170, v171
  v_perm_b32 v104, v12, v12, v76
  v_perm_b32 v105, v12, v12, v77
  v_perm_b32 v106, v13, v13, v76
  v_perm_b32 v107, v13, v13, v77
  v_exp_f32 v176, v176
  v_exp_f32 v177, v177
  v_exp_f32 v178, v178
  v_exp_f32 v179, v179
  v_cvt_pk_bf16_f32 v12, v172, v173
  v_cvt_pk_bf16_f32 v13, v174, v175
  v_perm_b32 v108, v12, v12, v76
  v_perm_b32 v109, v12, v12, v77
  v_perm_b32 v110, v13, v13, v76
  v_perm_b32 v111, v13, v13, v77
  v_exp_f32 v180, v180
  v_exp_f32 v181, v181
  v_exp_f32 v182, v182
  v_exp_f32 v183, v183
  v_cvt_pk_bf16_f32 v12, v176, v177
  v_cvt_pk_bf16_f32 v13, v178, v179
  v_perm_b32 v112, v12, v12, v76
  v_perm_b32 v113, v12, v12, v77
  v_perm_b32 v114, v13, v13, v76
  v_perm_b32 v115, v13, v13, v77
  v_exp_f32 v184, v184
  v_exp_f32 v185, v185
  v_exp_f32 v186, v186
  v_exp_f32 v187, v187
  v_cvt_pk_bf16_f32 v12, v180, v181
  v_cvt_pk_bf16_f32 v13, v182, v183
  v_perm_b32 v116, v12, v12, v76
  v_perm_b32 v117, v12, v12, v77
  v_perm_b32 v118, v13, v13, v76
  v_perm_b32 v119, v13, v13, v77
  v_exp_f32 v188, v188
  v_exp_f32 v189, v189
  v_exp_f32 v190, v190
  v_exp_f32 v191, v191
  v_cvt_pk_bf16_f32 v12, v184, v185
  v_cvt_pk_bf16_f32 v13, v186, v187
  v_perm_b32 v120, v12, v12, v76
  v_perm_b32 v121, v12, v12, v77
  v_perm_b32 v122, v13, v13, v76
  v_perm_b32 v123, v13, v13, v77
  s_nop 0
  v_cvt_pk_bf16_f32 v12, v188, v189
  v_cvt_pk_bf16_f32 v13, v190, v191
  v_perm_b32 v124, v12, v12, v76
  v_perm_b32 v125, v12, v12, v77
  v_perm_b32 v126, v13, v13, v76
  v_perm_b32 v127, v13, v13, v77
  s_nop 1
  v_mfma_f32_16x16x32_bf16 v[128:131], v[228:231], v[96:99], 0
  v_mfma_f32_16x16x32_bf16 v[160:163], v[78:81], v[96:99], 0
  v_mfma_f32_16x16x32_bf16 v[132:135], v[238:241], v[100:103], 0
  v_mfma_f32_16x16x32_bf16 v[164:167], v[78:81], v[100:103], 0
  v_mfma_f32_16x16x32_bf16 v[136:139], v[230:233], v[104:107], 0
  v_mfma_f32_16x16x32_bf16 v[168:171], v[78:81], v[104:107], 0
  v_mfma_f32_16x16x32_bf16 v[140:143], v[240:243], v[108:111], 0
  v_mfma_f32_16x16x32_bf16 v[172:175], v[78:81], v[108:111], 0
  v_mfma_f32_16x16x32_bf16 v[144:147], v[232:235], v[112:115], 0
  v_mfma_f32_16x16x32_bf16 v[176:179], v[78:81], v[112:115], 0
  v_mfma_f32_16x16x32_bf16 v[148:151], v[242:245], v[116:119], 0
  v_mfma_f32_16x16x32_bf16 v[180:183], v[78:81], v[116:119], 0
  v_mfma_f32_16x16x32_bf16 v[152:155], v[234:237], v[120:123], 0
  v_mfma_f32_16x16x32_bf16 v[184:187], v[78:81], v[120:123], 0
  v_mfma_f32_16x16x32_bf16 v[156:159], v[244:247], v[124:127], 0
  v_mfma_f32_16x16x32_bf16 v[188:191], v[78:81], v[124:127], 0
  s_nop 6
  v_rcp_f32 v4, v160
  v_rcp_f32 v5, v164
  v_rcp_f32 v6, v168
  v_rcp_f32 v7, v172
  v_rcp_f32 v8, v176
  v_rcp_f32 v9, v180
  v_rcp_f32 v10, v184
  v_rcp_f32 v11, v188
  s_nop 0
  v_pk_mul_f32 v[128:129], v[128:129], v[4:5] op_sel:[0,0] op_sel_hi:[1,0]
  v_pk_mul_f32 v[130:131], v[130:131], v[4:5] op_sel:[0,0] op_sel_hi:[1,0]
  v_pk_mul_f32 v[132:133], v[132:133], v[4:5] op_sel:[0,1] op_sel_hi:[1,1]
  v_pk_mul_f32 v[134:135], v[134:135], v[4:5] op_sel:[0,1] op_sel_hi:[1,1]
  v_pk_mul_f32 v[136:137], v[136:137], v[6:7] op_sel:[0,0] op_sel_hi:[1,0]
  v_pk_mul_f32 v[138:139], v[138:139], v[6:7] op_sel:[0,0] op_sel_hi:[1,0]
  v_pk_mul_f32 v[140:141], v[140:141], v[6:7] op_sel:[0,1] op_sel_hi:[1,1]
  v_pk_mul_f32 v[142:143], v[142:143], v[6:7] op_sel:[0,1] op_sel_hi:[1,1]
  v_pk_mul_f32 v[144:145], v[144:145], v[8:9] op_sel:[0,0] op_sel_hi:[1,0]
  v_pk_mul_f32 v[146:147], v[146:147], v[8:9] op_sel:[0,0] op_sel_hi:[1,0]
  v_pk_mul_f32 v[148:149], v[148:149], v[8:9] op_sel:[0,1] op_sel_hi:[1,1]
  v_pk_mul_f32 v[150:151], v[150:151], v[8:9] op_sel:[0,1] op_sel_hi:[1,1]
  v_pk_mul_f32 v[152:153], v[152:153], v[10:11] op_sel:[0,0] op_sel_hi:[1,0]
  v_pk_mul_f32 v[154:155], v[154:155], v[10:11] op_sel:[0,0] op_sel_hi:[1,0]
  v_pk_mul_f32 v[156:157], v[156:157], v[10:11] op_sel:[0,1] op_sel_hi:[1,1]
  v_pk_mul_f32 v[158:159], v[158:159], v[10:11] op_sel:[0,1] op_sel_hi:[1,1]
  v_cvt_pk_bf16_f32 v16, v128, v129
  v_cvt_pk_bf16_f32 v17, v130, v131
  v_cvt_pk_bf16_f32 v18, v132, v133
  v_cvt_pk_bf16_f32 v19, v134, v135
  buffer_store_dwordx4 v[16:19], v250, s[32:35], s71 offen offset:0 sc1
  v_cvt_pk_bf16_f32 v20, v136, v137
  v_cvt_pk_bf16_f32 v21, v138, v139
  v_cvt_pk_bf16_f32 v22, v140, v141
  v_cvt_pk_bf16_f32 v23, v142, v143
  buffer_store_dwordx4 v[20:23], v250, s[32:35], s71 offen offset:1024 sc1
  v_cvt_pk_bf16_f32 v24, v144, v145
  v_cvt_pk_bf16_f32 v25, v146, v147
  v_cvt_pk_bf16_f32 v26, v148, v149
  v_cvt_pk_bf16_f32 v27, v150, v151
  buffer_store_dwordx4 v[24:27], v250, s[32:35], s71 offen offset:2048 sc1
  v_cvt_pk_bf16_f32 v28, v152, v153
  v_cvt_pk_bf16_f32 v29, v154, v155
  v_cvt_pk_bf16_f32 v30, v156, v157
  v_cvt_pk_bf16_f32 v31, v158, v159
  buffer_store_dwordx4 v[28:31], v250, s[32:35], s71 offen offset:3072 sc1
  v_cmp_eq_u32 s[68:69], 0, v1
  s_nop 1
  s_and_saveexec_b64 s[66:67], s[68:69]
  buffer_store_dwordx2 v[56:57], v86, s[36:39], 0 offen sc1
  s_mov_b64 exec, s[66:67]
  v_mov_b32 v0, v93
  v_lshlrev_b32 v4, 4, v1
  s_lshl_b32 s66, s12, 12
  s_add_u32 s65, s40, 0
  s_and_b32 s65, s65, 3
  s_lshl_b32 s65, s65, 10
  s_add_u32 s65, s65, s66
  v_add_u32 v8, s65, v4
  s_add_u32 s65, s40, 1
  s_and_b32 s65, s65, 3
  s_lshl_b32 s65, s65, 10
  s_add_u32 s65, s65, s66
  v_add_u32 v9, s65, v4
  s_add_u32 s65, s40, 2
  s_and_b32 s65, s65, 3
  s_lshl_b32 s65, s65, 10
  s_add_u32 s65, s65, s66
  v_add_u32 v10, s65, v4
  s_add_u32 s65, s40, 3
  s_and_b32 s65, s65, 3
  s_lshl_b32 s65, s65, 10
  s_add_u32 s65, s65, s66
  v_add_u32 v11, s65, v4
  s_mov_b32 s16, s48
  s_and_b32 s17, s49, 0xffff
  s_mov_b32 s18, 2097152
  s_mov_b32 s19, 0x00020000
  s_waitcnt vmcnt(5)
  v_add_u32 v60, s96, v88
  v_add_u32 v61, s96, v89
  v_add_u32 v62, s96, v90
  v_add_u32 v63, s96, v91
  ds_read_b64_tr_b16 a[0:1], v60 offset:0
  ds_read_b64_tr_b16 a[2:3], v60 offset:2048
  ds_read_b64_tr_b16 a[4:5], v61 offset:0
  ds_read_b64_tr_b16 a[6:7], v61 offset:2048
  ds_read_b64_tr_b16 a[8:9], v62 offset:0
  ds_read_b64_tr_b16 a[10:11], v62 offset:2048
  ds_read_b64_tr_b16 a[12:13], v63 offset:0
  ds_read_b64_tr_b16 a[14:15], v63 offset:2048
  ds_read_b64_tr_b16 a[16:17], v60 offset:4096
  ds_read_b64_tr_b16 a[18:19], v60 offset:6144
  ds_read_b64_tr_b16 a[20:21], v61 offset:4096
  ds_read_b64_tr_b16 a[22:23], v61 offset:6144
  ds_read_b64_tr_b16 a[24:25], v62 offset:4096
  ds_read_b64_tr_b16 a[26:27], v62 offset:6144
  ds_read_b64_tr_b16 a[28:29], v63 offset:4096
  ds_read_b64_tr_b16 a[30:31], v63 offset:6144
  ds_read_b64_tr_b16 a[32:33], v60 offset:8192
  ds_read_b64_tr_b16 a[34:35], v60 offset:10240
  ds_read_b64_tr_b16 a[36:37], v61 offset:8192
  ds_read_b64_tr_b16 a[38:39], v61 offset:10240
  ds_read_b64_tr_b16 a[40:41], v62 offset:8192
  ds_read_b64_tr_b16 a[42:43], v62 offset:10240
  ds_read_b64_tr_b16 a[44:45], v63 offset:8192
  ds_read_b64_tr_b16 a[46:47], v63 offset:10240
  ds_read_b64_tr_b16 a[48:49], v60 offset:12288
  ds_read_b64_tr_b16 a[50:51], v60 offset:14336
  ds_read_b64_tr_b16 a[52:53], v61 offset:12288
  ds_read_b64_tr_b16 a[54:55], v61 offset:14336
  ds_read_b64_tr_b16 a[56:57], v62 offset:12288
  ds_read_b64_tr_b16 a[58:59], v62 offset:14336
  ds_read_b64_tr_b16 a[60:61], v63 offset:12288
  ds_read_b64_tr_b16 a[62:63], v63 offset:14336
  v_add_u32 v60, s97, v88
  v_add_u32 v61, s97, v89
  v_add_u32 v62, s97, v90
  v_add_u32 v63, s97, v91
  ds_read_b64_tr_b16 a[64:65], v60 offset:0
  ds_read_b64_tr_b16 a[66:67], v60 offset:2048
  ds_read_b64_tr_b16 a[68:69], v61 offset:0
  ds_read_b64_tr_b16 a[70:71], v61 offset:2048
  ds_read_b64_tr_b16 a[72:73], v62 offset:0
  ds_read_b64_tr_b16 a[74:75], v62 offset:2048
  ds_read_b64_tr_b16 a[76:77], v63 offset:0
  ds_read_b64_tr_b16 a[78:79], v63 offset:2048
  ds_read_b64_tr_b16 a[80:81], v60 offset:4096
  ds_read_b64_tr_b16 a[82:83], v60 offset:6144
  ds_read_b64_tr_b16 a[84:85], v61 offset:4096
  ds_read_b64_tr_b16 a[86:87], v61 offset:6144
  ds_read_b64_tr_b16 a[88:89], v62 offset:4096
  ds_read_b64_tr_b16 a[90:91], v62 offset:6144
  ds_read_b64_tr_b16 a[92:93], v63 offset:4096
  ds_read_b64_tr_b16 a[94:95], v63 offset:6144
  v_add_u32 v60, s98, v88
  v_add_u32 v61, s98, v89
  v_add_u32 v62, s98, v90
  v_add_u32 v63, s98, v91
  ds_read_b64_tr_b16 a[96:97], v60 offset:0
  ds_read_b64_tr_b16 a[98:99], v60 offset:2048
  ds_read_b64_tr_b16 a[100:101], v61 offset:0
  ds_read_b64_tr_b16 a[102:103], v61 offset:2048
  ds_read_b64_tr_b16 a[104:105], v62 offset:0
  ds_read_b64_tr_b16 a[106:107], v62 offset:2048
  ds_read_b64_tr_b16 a[108:109], v63 offset:0
  ds_read_b64_tr_b16 a[110:111], v63 offset:2048
  v_add_u32 v60, s99, v88
  v_add_u32 v61, s99, v89
  v_add_u32 v62, s99, v90
  v_add_u32 v63, s99, v91
  ds_read_b64_tr_b16 a[112:113], v60 offset:0
  ds_read_b64_tr_b16 a[114:115], v60 offset:2048
  ds_read_b64_tr_b16 a[116:117], v61 offset:0
  ds_read_b64_tr_b16 a[118:119], v61 offset:2048
  ds_read_b64_tr_b16 a[120:121], v62 offset:0
  ds_read_b64_tr_b16 a[122:123], v62 offset:2048
  ds_read_b64_tr_b16 a[124:125], v63 offset:0
  ds_read_b64_tr_b16 a[126:127], v63 offset:2048
  v_add_u32 v60, s100, v88
  v_add_u32 v61, s100, v89
  v_add_u32 v62, s100, v90
  v_add_u32 v63, s100, v91
  ds_read_b64_tr_b16 a[128:129], v60 offset:0
  ds_read_b64_tr_b16 a[130:131], v60 offset:2048
  ds_read_b64_tr_b16 a[132:133], v61 offset:0
  ds_read_b64_tr_b16 a[134:135], v61 offset:2048
  ds_read_b64_tr_b16 a[136:137], v62 offset:0
  ds_read_b64_tr_b16 a[138:139], v62 offset:2048
  ds_read_b64_tr_b16 a[140:141], v63 offset:0
  ds_read_b64_tr_b16 a[142:143], v63 offset:2048
  s_waitcnt lgkmcnt(0)
  s_lshl_b32 s45, s44, 15
  s_add_u32 s44, s44, 1
  s_cmp_eq_u32 s44, s15
  s_cselect_b32 s44, 0, s44
  s_add_u32 m0, s96, 0
  s_add_u32 s57, s45, 0
  s_nop 0
  buffer_load_dwordx4 v87, s[24:27], s57 offen lds
  s_add_u32 m0, s96, 1024
  s_add_u32 s57, s45, 8192
  s_nop 0
  buffer_load_dwordx4 v87, s[24:27], s57 offen lds
  s_add_u32 m0, s96, 2048
  s_add_u32 s57, s45, 16384
  s_nop 0
  buffer_load_dwordx4 v87, s[24:27], s57 offen lds
  s_add_u32 m0, s96, 3072
  s_add_u32 s57, s45, 24576
  s_nop 0
  buffer_load_dwordx4 v87, s[24:27], s57 offen lds
  s_waitcnt vmcnt(4)
  s_barrier
  v_mov_b32 v5, 1
  buffer_store_dword v5, v94, s[36:39], 0 offen sc1
  s_branch Lphase2
Lffn:
  s_add_u32 s67, s43, 8
  s_lshl_b32 s67, s67, 3
  s_lshl_b32 s66, s41, 7
  s_add_u32 s67, s67, s66
  s_lshl_b32 s66, s40, 1
  s_add_u32 s65, s67, s66
  s_lshl_b32 s66, s65, 10
  s_lshl_b32 s65, s65, 2
  v_lshlrev_b32 v5, 4, v1
  v_add_u32 v4, s66, v5
  v_mov_b32 v86, s65
  s_add_u32 s67, s67, 16384
  s_lshl_b32 s66, s41, 4
  v_cmp_eq_u32 s[28:29], 0, v0
  v_mov_b32 v7, 0x40000000
  v_mov_b32 v8, s67
  v_mov_b32 v95, s66
  v_cndmask_b32 v94, v7, v8, s[28:29]
  s_add_u32 s36, s10, 8388608
  s_addc_u32 s37, s11, 0
  s_and_b32 s37, s37, 0xffff
  s_mov_b32 s38, 32768
  s_mov_b32 s39, 0x00020000
  v_mov_b32 v7, 0
  buffer_store_dword v7, v94, s[36:39], 0 offen sc1
  s_cmp_eq_u32 s40, 0
  s_cselect_b64 s[4:5], 1, 0
  s_mov_b32 s28, s46
  s_and_b32 s29, s47, 0xffff
  s_mov_b32 s30, 1024
  s_mov_b32 s31, 0x00020000
  s_mov_b32 s24, s14
  s_and_b32 s25, s15, 0xffff
  s_mov_b32 s26, 2752
  s_mov_b32 s27, 0x00020000
  s_lshl_b32 s65, s64, 6
  s_mul_i32 s66, s53, 192
  s_add_u32 s65, s65, s66
  v_lshlrev_b32 v6, 3, v2
  v_add_u32 v6, s65, v6
  buffer_load_dwordx4 v[44:47], v4, s[16:19], 0 offen
  buffer_load_dwordx4 v[48:51], v4, s[16:19], 0 offen offset:1024
  buffer_load_dwordx4 v[52:55], v5, s[28:31], 0 offen
  buffer_load_dwordx2 v[58:59], v6, s[24:27], 0 offen offset:0
  buffer_load_dwordx2 v[60:61], v6, s[24:27], 0 offen offset:32
  buffer_load_dwordx2 v[62:63], v6, s[24:27], 0 offen offset:64
  buffer_load_dwordx2 v[64:65], v6, s[24:27], 0 offen offset:96
  buffer_load_dwordx2 v[66:67], v6, s[24:27], 0 offen offset:128
  buffer_load_dwordx2 v[68:69], v6, s[24:27], 0 offen offset:160
  v_lshrrev_b32 v7, 1, v3
  s_lshl_b32 s65, s52, 13
  v_or_b32 v8, 0, v2
  v_xor_b32 v8, v8, v7
  v_lshlrev_b32 v8, 4, v8
  v_lshl_add_u32 v8, v3, 7, v8
  v_add_u32 v27, s65, v8
  v_or_b32 v8, 4, v2
  v_xor_b32 v8, v8, v7
  v_lshlrev_b32 v8, 4, v8
  v_lshl_add_u32 v8, v3, 7, v8
  v_add_u32 v28, s65, v8
  v_bfe_u32 v7, v1, 2, 2
  v_and_b32 v8, 3, v1
  v_lshl_add_u32 v9, v2, 3, v7
  v_lshlrev_b32 v9, 7, v9
  v_and_b32 v10, 1, v8
  v_lshl_add_u32 v9, v10, 3, v9
  v_and_b32 v10, 2, v7
  v_and_b32 v11, 1, v2
  v_lshl_or_b32 v10, v11, 2, v10
  v_lshrrev_b32 v11, 1, v8
  v_xor_b32 v10, v10, v11
  s_mul_i32 s65, s53, 6
  s_add_u32 s65, s65, 0
  s_lshr_b32 s66, s65, 2
  s_and_b32 s65, s65, 3
  s_lshl_b32 s65, s65, 1
  s_lshl_b32 s66, s66, 13
  s_add_u32 s66, s66, 18432
  v_xor_b32 v11, s65, v10
  v_lshl_add_u32 v11, v11, 4, v9
  v_add_u32 v29, s66, v11
  s_mul_i32 s65, s53, 6
  s_add_u32 s65, s65, 1
  s_lshr_b32 s66, s65, 2
  s_add_u32 m0, s63, s56
  s_nop 0
  buffer_load_dwordx4 v16, s[16:19], s59 offen lds
  s_and_b32 s65, s65, 3
  s_lshl_b32 s65, s65, 1
  s_lshl_b32 s66, s66, 13
  s_add_u32 s66, s66, 18432
  v_xor_b32 v11, s65, v10
  v_lshl_add_u32 v11, v11, 4, v9
  v_add_u32 v30, s66, v11
  s_mul_i32 s65, s53, 6
  s_add_u32 s65, s65, 2
  s_lshr_b32 s66, s65, 2
  s_and_b32 s65, s65, 3
  s_lshl_b32 s65, s65, 1
  s_lshl_b32 s66, s66, 13
  s_add_u32 s66, s66, 18432
  v_xor_b32 v11, s65, v10
  v_lshl_add_u32 v11, v11, 4, v9
  v_add_u32 v31, s66, v11
  s_mul_i32 s65, s53, 6
  s_add_u32 s65, s65, 3
  s_lshr_b32 s66, s65, 2
  s_and_b32 s65, s65, 3
  s_lshl_b32 s65, s65, 1
  s_lshl_b32 s66, s66, 13
  s_add_u32 s66, s66, 18432
  v_xor_b32 v11, s65, v10
  v_lshl_add_u32 v11, v11, 4, v9
  v_add_u32 v32, s66, v11
  s_mul_i32 s65, s53, 6
  s_add_u32 s65, s65, 4
  s_lshr_b32 s66, s65, 2
  s_and_b32 s65, s65, 3
  s_lshl_b32 s65, s65, 1
  s_lshl_b32 s66, s66, 13
  s_add_u32 s66, s66, 18432
  v_xor_b32 v11, s65, v10
  v_lshl_add_u32 v11, v11, 4, v9
  s_add_u32 m0, m0, 1024
  s_nop 0
  buffer_load_dwordx4 v17, s[16:19], s59 offen lds
  v_add_u32 v33, s66, v11
  s_mul_i32 s65, s53, 6
  s_add_u32 s65, s65, 5
  s_lshr_b32 s66, s65, 2
  s_and_b32 s65, s65, 3
  s_lshl_b32 s65, s65, 1
  s_lshl_b32 s66, s66, 13
  s_add_u32 s66, s66, 18432
  v_xor_b32 v11, s65, v10
  v_lshl_add_u32 v11, v11, 4, v9
  v_add_u32 v34, s66, v11
  s_mov_b32 s32, s10
  s_and_b32 s33, s11, 0xffff
  s_mov_b32 s34, 7733248
  s_mov_b32 s35, 0x00020000
  s_and_b32 s65, s2, 7
  s_lshr_b32 s66, s2, 3
  s_lshr_b32 s12, s65, 1
  s_lshl_b32 s12, s12, 3
  s_lshr_b32 s67, s66, 2
  s_add_u32 s12, s12, s67
  s_and_b32 s13, s65, 1
  s_lshl_b32 s13, s13, 2
  s_and_b32 s67, s66, 3
  s_xor_b32 s67, s67, 3
  s_add_u32 s13, s13, s67
  s_mov_b32 s14, 0
  s_mov_b32 s15, 16
  s_cmp_eq_u32 s40, 1
  s_cselect_b32 s14, 16, s14
  s_cselect_b32 s15, 15, s15
  s_cmp_eq_u32 s40, 2
  s_cselect_b32 s14, 31, s14
  s_cselect_b32 s15, 14, s15
  s_cmp_eq_u32 s40, 3
  s_cselect_b32 s14, 45, s14
  s_cselect_b32 s15, 14, s15
  s_lshl_b32 s96, s40, 14
  s_add_u32 s96, s96, 86016
  s_lshl_b32 s97, s40, 13
  s_mul_i32 s65, s40, 12288
  s_add_u32 s65, s65, 43008
  s_add_u32 m0, m0, 1024
  s_nop 0
  buffer_load_dwordx4 v18, s[16:19], s59 offen lds
  s_add_u32 s98, s65, 0
  s_add_u32 s99, s65, 4096
  s_add_u32 s100, s65, 8192
  s_cmp_eq_u32 s40, 3
  s_cselect_b32 s99, 151552, s99
  s_cselect_b32 s100, 155648, s100
  s_mul_i32 s101, s40, 28672
  s_sub_u32 s65, s14, 16
  s_lshl_b32 s65, s65, 15
  s_add_u32 s67, s44, s65
  s_addc_u32 s68, s45, 0
  s_cmp_eq_u32 s40, 0
  s_cselect_b32 s24, s8, s67
  s_cselect_b32 s25, s9, s68
  s_and_b32 s25, s25, 0xffff
  s_lshl_b32 s26, s15, 15
  s_mov_b32 s27, 0x00020000
  s_mul_i32 s65, s14, 131072
  s_add_u32 s28, s10, s65
  s_addc_u32 s29, s11, 0
  s_and_b32 s29, s29, 0xffff
  s_mul_i32 s30, s15, 131072
  s_mov_b32 s31, 0x00020000
  s_and_b32 s65, s12, 7
  s_mul_i32 s65, s65, 2
  s_and_b32 s66, s13, 3
  s_mul_i32 s66, s66, 0
  s_add_u32 s65, s65, s66
  s_sub_u32 s66, s65, s15
  s_cmp_ge_u32 s65, s15
  s_cselect_b32 s44, s66, s65
  s_mov_b32 s8, s44
  v_lshrrev_b32 v7, 3, v1
  v_and_b32 v8, 7, v1
  v_lshlrev_b32 v9, 1, v2
  v_xor_b32 v8, v8, v9
  v_lshlrev_b32 v8, 4, v8
  v_lshl_add_u32 v7, v7, 10, v8
  s_lshl_b32 s65, s13, 7
  v_add_u32 v87, s65, v7
  v_bfe_u32 v7, v1, 2, 2
  v_and_b32 v8, 3, v1
  v_lshl_add_u32 v9, v2, 2, v7
  s_add_u32 m0, m0, 1024
  s_nop 0
  buffer_load_dwordx4 v19, s[16:19], s59 offen lds
  s_add_u32 s59, s59, 128
  s_and_b32 s59, s59, 1023
  v_bfe_u32 v10, v9, 1, 2
  v_lshlrev_b32 v10, 1, v10
  v_lshlrev_b32 v9, 7, v9
  v_and_b32 v11, 1, v8
  v_lshl_add_u32 v9, v11, 3, v9
  v_lshrrev_b32 v11, 1, v8
  v_xor_b32 v10, v10, v11
  v_xor_b32 v11, 0, v10
  v_lshl_add_u32 v88, v11, 4, v9
  v_xor_b32 v11, 2, v10
  v_lshl_add_u32 v89, v11, 4, v9
  v_xor_b32 v11, 4, v10
  v_lshl_add_u32 v90, v11, 4, v9
  v_xor_b32 v11, 6, v10
  v_lshl_add_u32 v91, v11, 4, v9
  s_lshr_b32 s65, s12, 1
  s_lshl_b32 s65, s65, 4
  v_mov_b32 v43, s65
  s_lshl_b32 s65, s12, 2
  s_add_u32 s65, s65, s40
  s_lshl_b32 s65, s65, 6
  v_lshlrev_b32 v7, 2, v3
  v_add_u32 v92, s65, v7
  s_lshl_b32 s65, s65, 8
  s_lshl_b32 s66, s13, 7
  s_add_u32 s65, s65, s66
  v_and_b32 v7, 1, v2
  v_lshlrev_b32 v7, 5, v7
  v_lshrrev_b32 v8, 1, v2
  v_lshl_add_u32 v7, v8, 4, v7
  v_lshl_add_u32 v7, v3, 10, v7
  v_add_u32 v93, s65, v7
  v_add_u32 v35, s54, v27
  v_add_u32 v37, s54, v29
  v_add_u32 v38, s54, v30
  v_add_u32 v39, s54, v31
  v_add_u32 v40, s54, v32
  v_add_u32 v41, s54, v33
  v_add_u32 v42, s54, v34
  v_add_u32 v36, s54, v28
  v_add_u32 v208, s54, v29
  v_add_u32 v209, s54, v30
  v_add_u32 v210, s54, v31
  v_add_u32 v211, s54, v32
  v_add_u32 v212, s54, v33
  v_add_u32 v213, s54, v34
  s_mov_b32 s0, 1069066811
  s_mov_b32 s1, 1069066811
  s_mul_i32 s71, s53, 3
  s_add_u32 s71, s71, s64
  s_add_u32 s71, s71, 16
  s_mul_i32 s71, s71, 131072
  s_lshl_b32 s65, s41, 3
  s_lshl_b32 s66, s52, 2
  s_add_u32 s65, s65, s66
  s_lshl_b32 s65, s65, 10
  v_lshlrev_b32 v250, 4, v1
  v_add_u32 v250, s65, v250
  s_waitcnt vmcnt(4)
  s_barrier
  ds_read_b64_tr_b16 a[20:21], v37 offset:0
  ds_read_b64_tr_b16 a[22:23], v37 offset:512
  ds_read_b128 a[0:3], v35 offset:0
  ds_read_b128 a[4:7], v35 offset:2048
  ds_read_b128 a[8:11], v35 offset:4096
  ds_read_b128 a[12:15], v35 offset:6144
  ds_read_b64_tr_b16 a[24:25], v38 offset:0
  ds_read_b64_tr_b16 a[26:27], v38 offset:512
  ds_read_b64_tr_b16 a[28:29], v39 offset:0
  ds_read_b64_tr_b16 a[30:31], v39 offset:512
  ds_read_b64_tr_b16 a[32:33], v40 offset:0
  ds_read_b64_tr_b16 a[34:35], v40 offset:512
  ds_read_b64_tr_b16 a[36:37], v41 offset:0
  ds_read_b64_tr_b16 a[38:39], v41 offset:512
  ds_read_b64_tr_b16 a[40:41], v42 offset:0
  ds_read_b64_tr_b16 a[42:43], v42 offset:512
  v_lshlrev_b32 v70, 16, v58
  v_and_b32 v71, 0xffff0000, v58
  v_lshlrev_b32 v72, 16, v59
  v_and_b32 v73, 0xffff0000, v59
  v_lshlrev_b32 v74, 16, v60
  v_and_b32 v75, 0xffff0000, v60
  v_lshlrev_b32 v76, 16, v61
  v_and_b32 v77, 0xffff0000, v61
  v_lshlrev_b32 v78, 16, v62
  v_and_b32 v79, 0xffff0000, v62
  v_lshlrev_b32 v80, 16, v63
  v_and_b32 v81, 0xffff0000, v63
  v_lshlrev_b32 v82, 16, v64
  v_and_b32 v83, 0xffff0000, v64
  v_lshlrev_b32 v84, 16, v65
  v_and_b32 v85, 0xffff0000, v65
  v_lshlrev_b32 v8, 16, v66
  v_and_b32 v9, 0xffff0000, v66
  v_lshlrev_b32 v10, 16, v67
  v_and_b32 v11, 0xffff0000, v67
  v_lshlrev_b32 v12, 16, v68
  v_and_b32 v13, 0xffff0000, v68
  v_lshlrev_b32 v14, 16, v69
  v_and_b32 v15, 0xffff0000, v69
  s_waitcnt lgkmcnt(0)
  v_mfma_f32_16x16x32_bf16 v[96:99], a[20:23], a[0:3], v[70:73]
  ds_read_b64_tr_b16 a[64:65], v208 offset:4096
  s_add_u32 m0, s63, s58
  v_dot2_f32_bf16 v56, v44, v52, 0
  v_dot2_f32_bf16 v57, v48, v52, 0
  v_mfma_f32_16x16x32_bf16 v[120:123], a[20:23], a[4:7], v[70:73]
  ds_read_b64_tr_b16 a[66:67], v208 offset:4608
  buffer_load_dwordx4 v21, s[20:23], s60 offen lds
  v_dot2_f32_bf16 v56, v45, v53, v56
  v_dot2_f32_bf16 v57, v49, v53, v57
  v_mfma_f32_16x16x32_bf16 v[144:147], a[20:23], a[8:11], v[70:73]
  ds_read_b128 a[44:47], v36 offset:0
  s_add_u32 m0, m0, 1024
  v_dot2_f32_bf16 v56, v46, v54, v56
  v_mfma_f32_16x16x32_bf16 v[168:171], a[20:23], a[12:15], v[70:73]
  ds_read_b128 a[48:51], v36 offset:2048
  buffer_load_dwordx4 v22, s[20:23], s60 offen lds
  v_dot2_f32_bf16 v57, v50, v54, v57
  v_dot2_f32_bf16 v56, v47, v55, v56
  v_mfma_f32_16x16x32_bf16 v[100:103], a[24:27], a[0:3], v[74:77]
  s_add_u32 m0, m0, 1024
  v_dot2_f32_bf16 v57, v51, v55, v57
  s_nop 0
  v_mfma_f32_16x16x32_bf16 v[124:127], a[24:27], a[4:7], v[74:77]
  ds_read_b128 a[52:55], v36 offset:4096
  buffer_load_dwordx4 v23, s[20:23], s60 offen lds
  s_nop 0
  v_mfma_f32_16x16x32_bf16 v[148:151], a[24:27], a[8:11], v[74:77]
  ds_read_b128 a[56:59], v36 offset:6144
  s_add_u32 m0, m0, 1024
  v_add_f32_dpp v56, v56, v56 row_ror:8 row_mask:0xf bank_mask:0xf
  v_add_f32_dpp v57, v57, v57 row_ror:8 row_mask:0xf bank_mask:0xf
  v_mfma_f32_16x16x32_bf16 v[172:175], a[24:27], a[12:15], v[74:77]
  ds_read_b64_tr_b16 a[68:69], v209 offset:4096
  buffer_load_dwordx4 v24, s[20:23], s60 offen lds
  v_add_f32_dpp v56, v56, v56 row_ror:4 row_mask:0xf bank_mask:0xf
  v_mfma_f32_16x16x32_bf16 v[104:107], a[28:31], a[0:3], v[78:81]
  ds_read_b64_tr_b16 a[70:71], v209 offset:4608
  v_add_f32_dpp v57, v57, v57 row_ror:4 row_mask:0xf bank_mask:0xf
  v_add_f32_dpp v56, v56, v56 row_ror:2 row_mask:0xf bank_mask:0xf
  v_mfma_f32_16x16x32_bf16 v[128:131], a[28:31], a[4:7], v[78:81]
  s_add_u32 m0, m0, 1024
  v_add_f32_dpp v57, v57, v57 row_ror:2 row_mask:0xf bank_mask:0xf
  v_add_f32_dpp v56, v56, v56 row_ror:1 row_mask:0xf bank_mask:0xf
  v_mfma_f32_16x16x32_bf16 v[152:155], a[28:31], a[8:11], v[78:81]
  ds_read_b64_tr_b16 a[72:73], v210 offset:4096
  buffer_load_dwordx4 v25, s[20:23], s60 offen lds
  v_add_f32_dpp v57, v57, v57 row_ror:1 row_mask:0xf bank_mask:0xf
  v_mfma_f32_16x16x32_bf16 v[176:179], a[28:31], a[12:15], v[78:81]
  ds_read_b64_tr_b16 a[74:75], v210 offset:4608
  s_add_u32 m0, m0, 1024
  v_mov_b32 v4, v56
  v_mov_b32 v5, v57
  v_mfma_f32_16x16x32_bf16 v[108:111], a[32:35], a[0:3], v[82:85]
  ds_read_b64_tr_b16 a[76:77], v211 offset:4096
  buffer_load_dwordx4 v26, s[20:23], s60 offen lds
  s_add_u32 s60, s60, s62
  s_cmp_eq_u32 s60, s22
  s_cselect_b32 s60, 0, s60
  v_permlane16_swap_b32 v56, v4
  v_mfma_f32_16x16x32_bf16 v[132:135], a[32:35], a[4:7], v[82:85]
  ds_read_b64_tr_b16 a[78:79], v211 offset:4608
  s_add_u32 m0, s55, s56
  v_permlane16_swap_b32 v57, v5
  v_add_u32 v35, s63, v27
  v_mfma_f32_16x16x32_bf16 v[156:159], a[32:35], a[8:11], v[82:85]
  buffer_load_dwordx4 v16, s[16:19], s59 offen lds
  v_add_u32 v37, s63, v29
  v_add_u32 v38, s63, v30
  v_mfma_f32_16x16x32_bf16 v[180:183], a[32:35], a[12:15], v[82:85]
  ds_read_b64_tr_b16 a[80:81], v212 offset:4096
  v_add_u32 v39, s63, v31
  v_mfma_f32_16x16x32_bf16 v[112:115], a[36:39], a[0:3], v[8:11]
  ds_read_b64_tr_b16 a[82:83], v212 offset:4608
  s_add_u32 m0, m0, 1024
  v_add_u32 v40, s63, v32
  v_add_u32 v41, s63, v33
  v_mfma_f32_16x16x32_bf16 v[136:139], a[36:39], a[4:7], v[8:11]
  ds_read_b64_tr_b16 a[84:85], v213 offset:4096
  buffer_load_dwordx4 v17, s[16:19], s59 offen lds
  v_add_u32 v42, s63, v34
  v_mfma_f32_16x16x32_bf16 v[160:163], a[36:39], a[8:11], v[8:11]
  ds_read_b64_tr_b16 a[86:87], v213 offset:4608
  s_add_u32 m0, m0, 1024
  v_mfma_f32_16x16x32_bf16 v[184:187], a[36:39], a[12:15], v[8:11]
  buffer_load_dwordx4 v18, s[16:19], s59 offen lds
  v_mfma_f32_16x16x32_bf16 v[116:119], a[40:43], a[0:3], v[12:15]
  s_add_u32 m0, m0, 1024
  v_mfma_f32_16x16x32_bf16 v[140:143], a[40:43], a[4:7], v[12:15]
  buffer_load_dwordx4 v19, s[16:19], s59 offen lds
  s_add_u32 s59, s59, 128
  s_and_b32 s59, s59, 1023
  v_mfma_f32_16x16x32_bf16 v[164:167], a[40:43], a[8:11], v[12:15]
  v_mfma_f32_16x16x32_bf16 v[188:191], a[40:43], a[12:15], v[12:15]
  s_waitcnt vmcnt(4) lgkmcnt(0)
  s_barrier
  v_mfma_f32_16x16x32_bf16 v[96:99], a[64:67], a[44:47], v[96:99]
  ds_read_b64_tr_b16 a[20:21], v37 offset:0
  v_add_f32 v56, v56, v4
  v_add_f32 v57, v57, v5
  v_mfma_f32_16x16x32_bf16 v[120:123], a[64:67], a[48:51], v[120:123]
  ds_read_b64_tr_b16 a[22:23], v37 offset:512
  s_add_u32 m0, s55, s58
  v_mov_b32 v4, v56
  v_mfma_f32_16x16x32_bf16 v[144:147], a[64:67], a[52:55], v[144:147]
  ds_read_b128 a[0:3], v35 offset:0
  buffer_load_dwordx4 v21, s[20:23], s60 offen lds
  v_mov_b32 v5, v57
  v_mfma_f32_16x16x32_bf16 v[168:171], a[64:67], a[56:59], v[168:171]
  ds_read_b128 a[4:7], v35 offset:2048
  s_add_u32 m0, m0, 1024
  v_permlane32_swap_b32 v56, v4
  v_mfma_f32_16x16x32_bf16 v[100:103], a[68:71], a[44:47], v[100:103]
  buffer_load_dwordx4 v22, s[20:23], s60 offen lds
  v_permlane32_swap_b32 v57, v5
  v_mfma_f32_16x16x32_bf16 v[124:127], a[68:71], a[48:51], v[124:127]
  ds_read_b128 a[8:11], v35 offset:4096
  s_add_u32 m0, m0, 1024
  v_add_f32 v56, v56, v4
  v_mfma_f32_16x16x32_bf16 v[148:151], a[68:71], a[52:55], v[148:151]
  ds_read_b128 a[12:15], v35 offset:6144
  buffer_load_dwordx4 v23, s[20:23], s60 offen lds
  v_add_f32 v57, v57, v5
  v_mul_f32 v56, 0xbfb8aa3b, v56
  v_mfma_f32_16x16x32_bf16 v[172:175], a[68:71], a[56:59], v[172:175]
  ds_read_b64_tr_b16 a[24:25], v38 offset:0
  s_add_u32 m0, m0, 1024
  v_mul_f32 v57, 0xbfb8aa3b, v57
  v_mfma_f32_16x16x32_bf16 v[104:107], a[72:75], a[44:47], v[104:107]
  ds_read_b64_tr_b16 a[26:27], v38 offset:512
  buffer_load_dwordx4 v24, s[20:23], s60 offen lds
  v_exp_f32 v56, v56
  v_mfma_f32_16x16x32_bf16 v[128:131], a[72:75], a[48:51], v[128:131]
  s_add_u32 m0, m0, 1024
  v_exp_f32 v57, v57
  v_mfma_f32_16x16x32_bf16 v[152:155], a[72:75], a[52:55], v[152:155]
  ds_read_b64_tr_b16 a[28:29], v39 offset:0
  buffer_load_dwordx4 v25, s[20:23], s60 offen lds
  v_add_f32 v56, 1.0, v56
  v_mfma_f32_16x16x32_bf16 v[176:179], a[72:75], a[56:59], v[176:179]
  ds_read_b64_tr_b16 a[30:31], v39 offset:512
  v_add_f32 v57, 1.0, v57
  v_mfma_f32_16x16x32_bf16 v[108:111], a[76:79], a[44:47], v[108:111]
  ds_read_b64_tr_b16 a[32:33], v40 offset:0
  s_add_u32 m0, m0, 1024
  v_rcp_f32 v56, v56
  v_mfma_f32_16x16x32_bf16 v[132:135], a[76:79], a[48:51], v[132:135]
  ds_read_b64_tr_b16 a[34:35], v40 offset:512
  buffer_load_dwordx4 v26, s[20:23], s60 offen lds
  s_add_u32 s60, s60, s62
  s_cmp_eq_u32 s60, s22
  s_cselect_b32 s60, 0, s60
  v_rcp_f32 v57, v57
  v_add_u32 v36, s63, v28
  v_mfma_f32_16x16x32_bf16 v[156:159], a[76:79], a[52:55], v[156:159]
  s_add_u32 m0, s54, s56
  v_add_u32 v208, s63, v29
  v_mfma_f32_16x16x32_bf16 v[180:183], a[76:79], a[56:59], v[180:183]
  ds_read_b64_tr_b16 a[36:37], v41 offset:0
  buffer_load_dwordx4 v16, s[16:19], s59 offen lds
  v_add_u32 v209, s63, v30
  v_mfma_f32_16x16x32_bf16 v[112:115], a[80:83], a[44:47], v[112:115]
  ds_read_b64_tr_b16 a[38:39], v41 offset:512
  s_add_u32 m0, m0, 1024
  v_add_u32 v210, s63, v31
  v_mfma_f32_16x16x32_bf16 v[136:139], a[80:83], a[48:51], v[136:139]
  ds_read_b64_tr_b16 a[40:41], v42 offset:0
  buffer_load_dwordx4 v17, s[16:19], s59 offen lds
  v_add_u32 v211, s63, v32
  v_mfma_f32_16x16x32_bf16 v[160:163], a[80:83], a[52:55], v[160:163]
  ds_read_b64_tr_b16 a[42:43], v42 offset:512
  s_add_u32 m0, m0, 1024
  v_add_u32 v212, s63, v33
  v_mfma_f32_16x16x32_bf16 v[184:187], a[80:83], a[56:59], v[184:187]
  buffer_load_dwordx4 v18, s[16:19], s59 offen lds
  v_add_u32 v213, s63, v34
  v_mfma_f32_16x16x32_bf16 v[116:119], a[84:87], a[44:47], v[116:119]
  s_add_u32 m0, m0, 1024
  v_mfma_f32_16x16x32_bf16 v[140:143], a[84:87], a[48:51], v[140:143]
  buffer_load_dwordx4 v19, s[16:19], s59 offen lds
  s_add_u32 s59, s59, 128
  s_and_b32 s59, s59, 1023
  s_mov_b32 s65, s55
  s_mov_b32 s55, s54
  v_mfma_f32_16x16x32_bf16 v[164:167], a[84:87], a[52:55], v[164:167]
  s_mov_b32 s54, s63
  s_mov_b32 s63, s65
  v_mfma_f32_16x16x32_bf16 v[188:191], a[84:87], a[56:59], v[188:191]
  s_waitcnt lgkmcnt(0)
  v_mfma_f32_16x16x32_bf16 v[96:99], a[20:23], a[0:3], v[96:99]
  ds_read_b64_tr_b16 a[64:65], v208 offset:4096
  v_add_u32 v35, s63, v27
  v_mfma_f32_16x16x32_bf16 v[120:123], a[20:23], a[4:7], v[120:123]
  ds_read_b64_tr_b16 a[66:67], v208 offset:4608
  s_add_u32 m0, s55, s58
  v_mfma_f32_16x16x32_bf16 v[144:147], a[20:23], a[8:11], v[144:147]
  ds_read_b128 a[44:47], v36 offset:0
  buffer_load_dwordx4 v21, s[20:23], s60 offen lds
  v_add_u32 v37, s63, v29
  v_mfma_f32_16x16x32_bf16 v[168:171], a[20:23], a[12:15], v[168:171]
  ds_read_b128 a[48:51], v36 offset:2048
  v_mfma_f32_16x16x32_bf16 v[100:103], a[24:27], a[0:3], v[100:103]
  s_add_u32 m0, m0, 1024
  v_mfma_f32_16x16x32_bf16 v[124:127], a[24:27], a[4:7], v[124:127]
  ds_read_b128 a[52:55], v36 offset:4096
  buffer_load_dwordx4 v22, s[20:23], s60 offen lds
  v_add_u32 v38, s63, v30
  v_mfma_f32_16x16x32_bf16 v[148:151], a[24:27], a[8:11], v[148:151]
  ds_read_b128 a[56:59], v36 offset:6144
  v_mfma_f32_16x16x32_bf16 v[172:175], a[24:27], a[12:15], v[172:175]
  ds_read_b64_tr_b16 a[68:69], v209 offset:4096
  v_add_u32 v39, s63, v31
  v_mfma_f32_16x16x32_bf16 v[104:107], a[28:31], a[0:3], v[104:107]
  ds_read_b64_tr_b16 a[70:71], v209 offset:4608
  s_add_u32 m0, m0, 1024
  v_mfma_f32_16x16x32_bf16 v[128:131], a[28:31], a[4:7], v[128:131]
  buffer_load_dwordx4 v23, s[20:23], s60 offen lds
  v_mfma_f32_16x16x32_bf16 v[152:155], a[28:31], a[8:11], v[152:155]
  ds_read_b64_tr_b16 a[72:73], v210 offset:4096
  v_add_u32 v40, s63, v32
  v_mfma_f32_16x16x32_bf16 v[176:179], a[28:31], a[12:15], v[176:179]
  ds_read_b64_tr_b16 a[74:75], v210 offset:4608
  v_mfma_f32_16x16x32_bf16 v[108:111], a[32:35], a[0:3], v[108:111]
  ds_read_b64_tr_b16 a[76:77], v211 offset:4096
  s_add_u32 m0, m0, 1024
  v_add_u32 v41, s63, v33
  v_mfma_f32_16x16x32_bf16 v[132:135], a[32:35], a[4:7], v[132:135]
  ds_read_b64_tr_b16 a[78:79], v211 offset:4608
  buffer_load_dwordx4 v24, s[20:23], s60 offen lds
  v_mfma_f32_16x16x32_bf16 v[156:159], a[32:35], a[8:11], v[156:159]
  v_mfma_f32_16x16x32_bf16 v[180:183], a[32:35], a[12:15], v[180:183]
  ds_read_b64_tr_b16 a[80:81], v212 offset:4096
  s_add_u32 m0, m0, 1024
  v_add_u32 v42, s63, v34
  v_mfma_f32_16x16x32_bf16 v[112:115], a[36:39], a[0:3], v[112:115]
  ds_read_b64_tr_b16 a[82:83], v212 offset:4608
  buffer_load_dwordx4 v25, s[20:23], s60 offen lds
  v_mfma_f32_16x16x32_bf16 v[136:139], a[36:39], a[4:7], v[136:139]
  ds_read_b64_tr_b16 a[84:85], v213 offset:4096
  v_mfma_f32_16x16x32_bf16 v[160:163], a[36:39], a[8:11], v[160:163]
  ds_read_b64_tr_b16 a[86:87], v213 offset:4608
  v_mfma_f32_16x16x32_bf16 v[184:187], a[36:39], a[12:15], v[184:187]
  s_add_u32 m0, m0, 1024
  v_mfma_f32_16x16x32_bf16 v[116:119], a[40:43], a[0:3], v[116:119]
  buffer_load_dwordx4 v26, s[20:23], s60 offen lds
  s_add_u32 s60, s60, s62
  s_cmp_eq_u32 s60, s22
  s_cselect_b32 s60, 0, s60
  v_mfma_f32_16x16x32_bf16 v[140:143], a[40:43], a[4:7], v[140:143]
  v_mfma_f32_16x16x32_bf16 v[164:167], a[40:43], a[8:11], v[164:167]
  v_mfma_f32_16x16x32_bf16 v[188:191], a[40:43], a[12:15], v[188:191]
  s_waitcnt vmcnt(10) lgkmcnt(0)
  s_barrier
  v_mfma_f32_16x16x32_bf16 v[96:99], a[64:67], a[44:47], v[96:99]
  ds_read_b64_tr_b16 a[20:21], v37 offset:0
  v_mov_b32 v7, 1
  s_and_saveexec_b64 s[6:7], s[4:5]
  s_cbranch_execz 2f
  global_atomic_add v95, v7, s[50:51] sc1
2:
  s_mov_b64 exec, s[6:7]
  v_mfma_f32_16x16x32_bf16 v[120:123], a[64:67], a[48:51], v[120:123]
  ds_read_b64_tr_b16 a[22:23], v37 offset:512
  s_add_u32 m0, s54, s56
  v_mfma_f32_16x16x32_bf16 v[144:147], a[64:67], a[52:55], v[144:147]
  ds_read_b128 a[0:3], v35 offset:0
  buffer_load_dwordx4 v16, s[16:19], s59 offen lds
  v_add_u32 v36, s63, v28
  v_mfma_f32_16x16x32_bf16 v[168:171], a[64:67], a[56:59], v[168:171]
  ds_read_b128 a[4:7], v35 offset:2048
  v_mfma_f32_16x16x32_bf16 v[100:103], a[68:71], a[44:47], v[100:103]
  v_mfma_f32_16x16x32_bf16 v[124:127], a[68:71], a[48:51], v[124:127]
  ds_read_b128 a[8:11], v35 offset:4096
  s_add_u32 m0, m0, 1024
  v_add_u32 v208, s63, v29
  v_mfma_f32_16x16x32_bf16 v[148:151], a[68:71], a[52:55], v[148:151]
  ds_read_b128 a[12:15], v35 offset:6144
  buffer_load_dwordx4 v17, s[16:19], s59 offen lds
  v_mfma_f32_16x16x32_bf16 v[172:175], a[68:71], a[56:59], v[172:175]
  ds_read_b64_tr_b16 a[24:25], v38 offset:0
  v_add_u32 v209, s63, v30
  v_mfma_f32_16x16x32_bf16 v[104:107], a[72:75], a[44:47], v[104:107]
  ds_read_b64_tr_b16 a[26:27], v38 offset:512
  v_mfma_f32_16x16x32_bf16 v[128:131], a[72:75], a[48:51], v[128:131]
  s_add_u32 m0, m0, 1024
  v_mfma_f32_16x16x32_bf16 v[152:155], a[72:75], a[52:55], v[152:155]
  ds_read_b64_tr_b16 a[28:29], v39 offset:0
  buffer_load_dwordx4 v18, s[16:19], s59 offen lds
  v_add_u32 v210, s63, v31
  v_mfma_f32_16x16x32_bf16 v[176:179], a[72:75], a[56:59], v[176:179]
  ds_read_b64_tr_b16 a[30:31], v39 offset:512
  v_mfma_f32_16x16x32_bf16 v[108:111], a[76:79], a[44:47], v[108:111]
  ds_read_b64_tr_b16 a[32:33], v40 offset:0
  v_add_u32 v211, s63, v32
  v_mfma_f32_16x16x32_bf16 v[132:135], a[76:79], a[48:51], v[132:135]
  ds_read_b64_tr_b16 a[34:35], v40 offset:512
  v_mfma_f32_16x16x32_bf16 v[156:159], a[76:79], a[52:55], v[156:159]
  s_add_u32 m0, m0, 1024
  v_mfma_f32_16x16x32_bf16 v[180:183], a[76:79], a[56:59], v[180:183]
  ds_read_b64_tr_b16 a[36:37], v41 offset:0
  buffer_load_dwordx4 v19, s[16:19], s59 offen lds
  v_add_u32 v212, s63, v33
  v_mfma_f32_16x16x32_bf16 v[112:115], a[80:83], a[44:47], v[112:115]
  ds_read_b64_tr_b16 a[38:39], v41 offset:512
  v_mfma_f32_16x16x32_bf16 v[136:139], a[80:83], a[48:51], v[136:139]
  ds_read_b64_tr_b16 a[40:41], v42 offset:0
  v_add_u32 v213, s63, v34
  v_mfma_f32_16x16x32_bf16 v[160:163], a[80:83], a[52:55], v[160:163]
  ds_read_b64_tr_b16 a[42:43], v42 offset:512
  s_add_u32 m0, s54, s58
  v_mfma_f32_16x16x32_bf16 v[184:187], a[80:83], a[56:59], v[184:187]
  buffer_load_dwordx4 v21, s[20:23], s60 offen lds
  v_mfma_f32_16x16x32_bf16 v[116:119], a[84:87], a[44:47], v[116:119]
  s_mov_b32 s61, s60
  s_add_u32 s59, s59, 128
  s_and_b32 s59, s59, 1023
  s_add_u32 s60, s60, s62
  s_cmp_eq_u32 s60, s22
  s_cselect_b32 s60, 0, s60
  v_mfma_f32_16x16x32_bf16 v[140:143], a[84:87], a[48:51], v[140:143]
  s_mov_b32 s65, s55
  s_mov_b32 s55, s54
  v_mfma_f32_16x16x32_bf16 v[164:167], a[84:87], a[52:55], v[164:167]
  s_mov_b32 s54, s63
  s_mov_b32 s63, s65
  v_mfma_f32_16x16x32_bf16 v[188:191], a[84:87], a[56:59], v[188:191]
  s_waitcnt lgkmcnt(0)
  s_mov_b32 s66, 2
Lffn_loop:
  v_mfma_f32_16x16x32_bf16 v[96:99], a[20:23], a[0:3], v[96:99]
  ds_read_b64_tr_b16 a[64:65], v208 offset:4096
  v_add_u32 v35, s63, v27
  v_mfma_f32_16x16x32_bf16 v[120:123], a[20:23], a[4:7], v[120:123]
  ds_read_b64_tr_b16 a[66:67], v208 offset:4608
  s_add_u32 m0, s55, s58
  s_add_u32 m0, m0, 1024
  v_mfma_f32_16x16x32_bf16 v[144:147], a[20:23], a[8:11], v[144:147]
  ds_read_b128 a[44:47], v36 offset:0
  buffer_load_dwordx4 v22, s[20:23], s61 offen lds
  v_add_u32 v37, s63, v29
  v_mfma_f32_16x16x32_bf16 v[168:171], a[20:23], a[12:15], v[168:171]
  ds_read_b128 a[48:51], v36 offset:2048
  v_mfma_f32_16x16x32_bf16 v[100:103], a[24:27], a[0:3], v[100:103]
  v_mfma_f32_16x16x32_bf16 v[124:127], a[24:27], a[4:7], v[124:127]
  ds_read_b128 a[52:55], v36 offset:4096
  s_add_u32 m0, m0, 1024
  v_add_u32 v38, s63, v30
  v_mfma_f32_16x16x32_bf16 v[148:151], a[24:27], a[8:11], v[148:151]
  ds_read_b128 a[56:59], v36 offset:6144
  buffer_load_dwordx4 v23, s[20:23], s61 offen lds
  v_mfma_f32_16x16x32_bf16 v[172:175], a[24:27], a[12:15], v[172:175]
  ds_read_b64_tr_b16 a[68:69], v209 offset:4096
  v_add_u32 v39, s63, v31
  v_mfma_f32_16x16x32_bf16 v[104:107], a[28:31], a[0:3], v[104:107]
  ds_read_b64_tr_b16 a[70:71], v209 offset:4608
  v_mfma_f32_16x16x32_bf16 v[128:131], a[28:31], a[4:7], v[128:131]
  s_add_u32 m0, m0, 1024
  v_mfma_f32_16x16x32_bf16 v[152:155], a[28:31], a[8:11], v[152:155]
  ds_read_b64_tr_b16 a[72:73], v210 offset:4096
  buffer_load_dwordx4 v24, s[20:23], s61 offen lds
  v_add_u32 v40, s63, v32
  v_mfma_f32_16x16x32_bf16 v[176:179], a[28:31], a[12:15], v[176:179]
  ds_read_b64_tr_b16 a[74:75], v210 offset:4608
  v_mfma_f32_16x16x32_bf16 v[108:111], a[32:35], a[0:3], v[108:111]
  ds_read_b64_tr_b16 a[76:77], v211 offset:4096
  v_add_u32 v41, s63, v33
  v_mfma_f32_16x16x32_bf16 v[132:135], a[32:35], a[4:7], v[132:135]
  ds_read_b64_tr_b16 a[78:79], v211 offset:4608
  v_mfma_f32_16x16x32_bf16 v[156:159], a[32:35], a[8:11], v[156:159]
  s_add_u32 m0, m0, 1024
  v_mfma_f32_16x16x32_bf16 v[180:183], a[32:35], a[12:15], v[180:183]
  ds_read_b64_tr_b16 a[80:81], v212 offset:4096
  buffer_load_dwordx4 v25, s[20:23], s61 offen lds
  v_add_u32 v42, s63, v34
  v_mfma_f32_16x16x32_bf16 v[112:115], a[36:39], a[0:3], v[112:115]
  ds_read_b64_tr_b16 a[82:83], v212 offset:4608
  v_mfma_f32_16x16x32_bf16 v[136:139], a[36:39], a[4:7], v[136:139]
  ds_read_b64_tr_b16 a[84:85], v213 offset:4096
  v_mfma_f32_16x16x32_bf16 v[160:163], a[36:39], a[8:11], v[160:163]
  ds_read_b64_tr_b16 a[86:87], v213 offset:4608
  s_add_u32 m0, m0, 1024
  v_mfma_f32_16x16x32_bf16 v[184:187], a[36:39], a[12:15], v[184:187]
  buffer_load_dwordx4 v26, s[20:23], s61 offen lds
  v_mfma_f32_16x16x32_bf16 v[116:119], a[40:43], a[0:3], v[116:119]
  v_mfma_f32_16x16x32_bf16 v[140:143], a[40:43], a[4:7], v[140:143]
  v_mfma_f32_16x16x32_bf16 v[164:167], a[40:43], a[8:11], v[164:167]
  v_mfma_f32_16x16x32_bf16 v[188:191], a[40:43], a[12:15], v[188:191]
  s_waitcnt vmcnt(10) lgkmcnt(0)
  s_barrier
  v_mfma_f32_16x16x32_bf16 v[96:99], a[64:67], a[44:47], v[96:99]
  ds_read_b64_tr_b16 a[20:21], v37 offset:0
  v_add_u32 v36, s63, v28
  v_mfma_f32_16x16x32_bf16 v[120:123], a[64:67], a[48:51], v[120:123]
  ds_read_b64_tr_b16 a[22:23], v37 offset:512
  s_add_u32 m0, s54, s56
  v_mfma_f32_16x16x32_bf16 v[144:147], a[64:67], a[52:55], v[144:147]
  ds_read_b128 a[0:3], v35 offset:0
  buffer_load_dwordx4 v16, s[16:19], s59 offen lds
  v_add_u32 v208, s63, v29
  v_mfma_f32_16x16x32_bf16 v[168:171], a[64:67], a[56:59], v[168:171]
  ds_read_b128 a[4:7], v35 offset:2048
  v_mfma_f32_16x16x32_bf16 v[100:103], a[68:71], a[44:47], v[100:103]
  v_mfma_f32_16x16x32_bf16 v[124:127], a[68:71], a[48:51], v[124:127]
  ds_read_b128 a[8:11], v35 offset:4096
  s_add_u32 m0, m0, 1024
  v_add_u32 v209, s63, v30
  v_mfma_f32_16x16x32_bf16 v[148:151], a[68:71], a[52:55], v[148:151]
  ds_read_b128 a[12:15], v35 offset:6144
  buffer_load_dwordx4 v17, s[16:19], s59 offen lds
  v_mfma_f32_16x16x32_bf16 v[172:175], a[68:71], a[56:59], v[172:175]
  ds_read_b64_tr_b16 a[24:25], v38 offset:0
  v_mfma_f32_16x16x32_bf16 v[104:107], a[72:75], a[44:47], v[104:107]
  ds_read_b64_tr_b16 a[26:27], v38 offset:512
  v_add_u32 v210, s63, v31
  v_mfma_f32_16x16x32_bf16 v[128:131], a[72:75], a[48:51], v[128:131]
  s_add_u32 m0, m0, 1024
  v_mfma_f32_16x16x32_bf16 v[152:155], a[72:75], a[52:55], v[152:155]
  ds_read_b64_tr_b16 a[28:29], v39 offset:0
  buffer_load_dwordx4 v18, s[16:19], s59 offen lds
  v_mfma_f32_16x16x32_bf16 v[176:179], a[72:75], a[56:59], v[176:179]
  ds_read_b64_tr_b16 a[30:31], v39 offset:512
  v_add_u32 v211, s63, v32
  v_mfma_f32_16x16x32_bf16 v[108:111], a[76:79], a[44:47], v[108:111]
  ds_read_b64_tr_b16 a[32:33], v40 offset:0
  v_mfma_f32_16x16x32_bf16 v[132:135], a[76:79], a[48:51], v[132:135]
  ds_read_b64_tr_b16 a[34:35], v40 offset:512
  v_mfma_f32_16x16x32_bf16 v[156:159], a[76:79], a[52:55], v[156:159]
  s_add_u32 m0, m0, 1024
  v_add_u32 v212, s63, v33
  v_mfma_f32_16x16x32_bf16 v[180:183], a[76:79], a[56:59], v[180:183]
  ds_read_b64_tr_b16 a[36:37], v41 offset:0
  buffer_load_dwordx4 v19, s[16:19], s59 offen lds
  v_mfma_f32_16x16x32_bf16 v[112:115], a[80:83], a[44:47], v[112:115]
  ds_read_b64_tr_b16 a[38:39], v41 offset:512
  v_mfma_f32_16x16x32_bf16 v[136:139], a[80:83], a[48:51], v[136:139]
  ds_read_b64_tr_b16 a[40:41], v42 offset:0
  v_add_u32 v213, s63, v34
  v_mfma_f32_16x16x32_bf16 v[160:163], a[80:83], a[52:55], v[160:163]
  ds_read_b64_tr_b16 a[42:43], v42 offset:512
  s_add_u32 m0, s54, s58
  v_mfma_f32_16x16x32_bf16 v[184:187], a[80:83], a[56:59], v[184:187]
  buffer_load_dwordx4 v21, s[20:23], s60 offen lds
  s_mov_b32 s61, s60
  s_add_u32 s59, s59, 128
  s_and_b32 s59, s59, 1023
  s_add_u32 s60, s60, s62
  s_cmp_eq_u32 s60, s22
  s_cselect_b32 s60, 0, s60
  v_mfma_f32_16x16x32_bf16 v[116:119], a[84:87], a[44:47], v[116:119]
  s_mov_b32 s65, s55
  s_mov_b32 s55, s54
  v_mfma_f32_16x16x32_bf16 v[140:143], a[84:87], a[48:51], v[140:143]
  s_mov_b32 s54, s63
  s_mov_b32 s63, s65
  v_mfma_f32_16x16x32_bf16 v[164:167], a[84:87], a[52:55], v[164:167]
  s_add_u32 s66, s66, 1
  s_cmp_lt_u32 s66, 5
  v_mfma_f32_16x16x32_bf16 v[188:191], a[84:87], a[56:59], v[188:191]
  s_waitcnt lgkmcnt(0)
  s_cbranch_scc1 Lffn_loop
  v_mfma_f32_16x16x32_bf16 v[96:99], a[20:23], a[0:3], v[96:99]
  ds_read_b64_tr_b16 a[64:65], v208 offset:4096
  v_add_u32 v35, s63, v27
  v_mfma_f32_16x16x32_bf16 v[120:123], a[20:23], a[4:7], v[120:123]
  ds_read_b64_tr_b16 a[66:67], v208 offset:4608
  s_add_u32 m0, s55, s58
  s_add_u32 m0, m0, 1024
  v_mfma_f32_16x16x32_bf16 v[144:147], a[20:23], a[8:11], v[144:147]
  ds_read_b128 a[44:47], v36 offset:0
  buffer_load_dwordx4 v22, s[20:23], s61 offen lds
  v_add_u32 v37, s63, v29
  v_mfma_f32_16x16x32_bf16 v[168:171], a[20:23], a[12:15], v[168:171]
  ds_read_b128 a[48:51], v36 offset:2048
  v_mfma_f32_16x16x32_bf16 v[100:103], a[24:27], a[0:3], v[100:103]
  v_mfma_f32_16x16x32_bf16 v[124:127], a[24:27], a[4:7], v[124:127]
  ds_read_b128 a[52:55], v36 offset:4096
  s_add_u32 m0, m0, 1024
  v_add_u32 v38, s63, v30
  v_mfma_f32_16x16x32_bf16 v[148:151], a[24:27], a[8:11], v[148:151]
  ds_read_b128 a[56:59], v36 offset:6144
  buffer_load_dwordx4 v23, s[20:23], s61 offen lds
  v_mfma_f32_16x16x32_bf16 v[172:175], a[24:27], a[12:15], v[172:175]
  ds_read_b64_tr_b16 a[68:69], v209 offset:4096
  v_add_u32 v39, s63, v31
  v_mfma_f32_16x16x32_bf16 v[104:107], a[28:31], a[0:3], v[104:107]
  ds_read_b64_tr_b16 a[70:71], v209 offset:4608
  v_mfma_f32_16x16x32_bf16 v[128:131], a[28:31], a[4:7], v[128:131]
  s_add_u32 m0, m0, 1024
  v_mfma_f32_16x16x32_bf16 v[152:155], a[28:31], a[8:11], v[152:155]
  ds_read_b64_tr_b16 a[72:73], v210 offset:4096
  buffer_load_dwordx4 v24, s[20:23], s61 offen lds
  v_add_u32 v40, s63, v32
  v_mfma_f32_16x16x32_bf16 v[176:179], a[28:31], a[12:15], v[176:179]
  ds_read_b64_tr_b16 a[74:75], v210 offset:4608
  v_mfma_f32_16x16x32_bf16 v[108:111], a[32:35], a[0:3], v[108:111]
  ds_read_b64_tr_b16 a[76:77], v211 offset:4096
  v_add_u32 v41, s63, v33
  v_mfma_f32_16x16x32_bf16 v[132:135], a[32:35], a[4:7], v[132:135]
  ds_read_b64_tr_b16 a[78:79], v211 offset:4608
  v_mfma_f32_16x16x32_bf16 v[156:159], a[32:35], a[8:11], v[156:159]
  s_add_u32 m0, m0, 1024
  v_mfma_f32_16x16x32_bf16 v[180:183], a[32:35], a[12:15], v[180:183]
  ds_read_b64_tr_b16 a[80:81], v212 offset:4096
  buffer_load_dwordx4 v25, s[20:23], s61 offen lds
  v_add_u32 v42, s63, v34
  v_mfma_f32_16x16x32_bf16 v[112:115], a[36:39], a[0:3], v[112:115]
  ds_read_b64_tr_b16 a[82:83], v212 offset:4608
  v_mfma_f32_16x16x32_bf16 v[136:139], a[36:39], a[4:7], v[136:139]
  ds_read_b64_tr_b16 a[84:85], v213 offset:4096
  v_mfma_f32_16x16x32_bf16 v[160:163], a[36:39], a[8:11], v[160:163]
  ds_read_b64_tr_b16 a[86:87], v213 offset:4608
  s_add_u32 m0, m0, 1024
  v_mfma_f32_16x16x32_bf16 v[184:187], a[36:39], a[12:15], v[184:187]
  buffer_load_dwordx4 v26, s[20:23], s61 offen lds
  v_mfma_f32_16x16x32_bf16 v[116:119], a[40:43], a[0:3], v[116:119]
  v_mfma_f32_16x16x32_bf16 v[140:143], a[40:43], a[4:7], v[140:143]
  v_mfma_f32_16x16x32_bf16 v[164:167], a[40:43], a[8:11], v[164:167]
  v_mfma_f32_16x16x32_bf16 v[188:191], a[40:43], a[12:15], v[188:191]
  s_waitcnt vmcnt(10) lgkmcnt(0)
  s_barrier
  v_mfma_f32_16x16x32_bf16 v[96:99], a[64:67], a[44:47], v[96:99]
  ds_read_b64_tr_b16 a[20:21], v37 offset:0
  v_add_u32 v36, s63, v28
  v_mfma_f32_16x16x32_bf16 v[120:123], a[64:67], a[48:51], v[120:123]
  ds_read_b64_tr_b16 a[22:23], v37 offset:512
  s_lshl_b32 s45, s44, 15
  s_add_u32 s44, s44, 1
  s_cmp_eq_u32 s44, s15
  s_cselect_b32 s44, 0, s44
  s_add_u32 m0, s96, 0
  s_add_u32 s57, s45, 0
  v_mfma_f32_16x16x32_bf16 v[144:147], a[64:67], a[52:55], v[144:147]
  ds_read_b128 a[0:3], v35 offset:0
  buffer_load_dwordx4 v87, s[24:27], s57 offen lds
  v_add_u32 v208, s63, v29
  v_mfma_f32_16x16x32_bf16 v[168:171], a[64:67], a[56:59], v[168:171]
  ds_read_b128 a[4:7], v35 offset:2048
  v_mfma_f32_16x16x32_bf16 v[100:103], a[68:71], a[44:47], v[100:103]
  s_add_u32 m0, s96, 1024
  s_add_u32 s57, s45, 8192
  v_mfma_f32_16x16x32_bf16 v[124:127], a[68:71], a[48:51], v[124:127]
  ds_read_b128 a[8:11], v35 offset:4096
  buffer_load_dwordx4 v87, s[24:27], s57 offen lds
  v_add_u32 v209, s63, v30
  v_mfma_f32_16x16x32_bf16 v[148:151], a[68:71], a[52:55], v[148:151]
  ds_read_b128 a[12:15], v35 offset:6144
  v_mfma_f32_16x16x32_bf16 v[172:175], a[68:71], a[56:59], v[172:175]
  ds_read_b64_tr_b16 a[24:25], v38 offset:0
  v_mfma_f32_16x16x32_bf16 v[104:107], a[72:75], a[44:47], v[104:107]
  ds_read_b64_tr_b16 a[26:27], v38 offset:512
  s_add_u32 m0, s96, 2048
  s_add_u32 s57, s45, 16384
  v_add_u32 v210, s63, v31
  v_mfma_f32_16x16x32_bf16 v[128:131], a[72:75], a[48:51], v[128:131]
  buffer_load_dwordx4 v87, s[24:27], s57 offen lds
  v_mfma_f32_16x16x32_bf16 v[152:155], a[72:75], a[52:55], v[152:155]
  ds_read_b64_tr_b16 a[28:29], v39 offset:0
  v_mfma_f32_16x16x32_bf16 v[176:179], a[72:75], a[56:59], v[176:179]
  ds_read_b64_tr_b16 a[30:31], v39 offset:512
  v_add_u32 v211, s63, v32
  v_mfma_f32_16x16x32_bf16 v[108:111], a[76:79], a[44:47], v[108:111]
  ds_read_b64_tr_b16 a[32:33], v40 offset:0
  s_add_u32 m0, s96, 3072
  s_add_u32 s57, s45, 24576
  v_mfma_f32_16x16x32_bf16 v[132:135], a[76:79], a[48:51], v[132:135]
  ds_read_b64_tr_b16 a[34:35], v40 offset:512
  buffer_load_dwordx4 v87, s[24:27], s57 offen lds
  v_mfma_f32_16x16x32_bf16 v[156:159], a[76:79], a[52:55], v[156:159]
  v_add_u32 v212, s63, v33
  v_mfma_f32_16x16x32_bf16 v[180:183], a[76:79], a[56:59], v[180:183]
  ds_read_b64_tr_b16 a[36:37], v41 offset:0
  s_lshl_b32 s45, s44, 15
  s_add_u32 s44, s44, 1
  s_cmp_eq_u32 s44, s15
  s_cselect_b32 s44, 0, s44
  s_add_u32 m0, s96, 4096
  s_add_u32 s57, s45, 0
  v_mfma_f32_16x16x32_bf16 v[112:115], a[80:83], a[44:47], v[112:115]
  ds_read_b64_tr_b16 a[38:39], v41 offset:512
  buffer_load_dwordx4 v87, s[24:27], s57 offen lds
  v_mfma_f32_16x16x32_bf16 v[136:139], a[80:83], a[48:51], v[136:139]
  ds_read_b64_tr_b16 a[40:41], v42 offset:0
  v_add_u32 v213, s63, v34
  v_mfma_f32_16x16x32_bf16 v[160:163], a[80:83], a[52:55], v[160:163]
  ds_read_b64_tr_b16 a[42:43], v42 offset:512
  v_mfma_f32_16x16x32_bf16 v[184:187], a[80:83], a[56:59], v[184:187]
  s_add_u32 m0, s96, 5120
  s_add_u32 s57, s45, 8192
  v_mfma_f32_16x16x32_bf16 v[116:119], a[84:87], a[44:47], v[116:119]
  buffer_load_dwordx4 v87, s[24:27], s57 offen lds
  v_mfma_f32_16x16x32_bf16 v[140:143], a[84:87], a[48:51], v[140:143]
  s_mov_b32 s65, s55
  s_mov_b32 s55, s54
  v_mfma_f32_16x16x32_bf16 v[164:167], a[84:87], a[52:55], v[164:167]
  s_mov_b32 s54, s63
  s_mov_b32 s63, s65
  v_mfma_f32_16x16x32_bf16 v[188:191], a[84:87], a[56:59], v[188:191]
  s_waitcnt lgkmcnt(0)
  v_mfma_f32_16x16x32_bf16 v[96:99], a[20:23], a[0:3], v[96:99]
  ds_read_b64_tr_b16 a[64:65], v208 offset:4096
  v_add_u32 v35, s63, v27
  v_mfma_f32_16x16x32_bf16 v[120:123], a[20:23], a[4:7], v[120:123]
  ds_read_b64_tr_b16 a[66:67], v208 offset:4608
  s_add_u32 m0, s96, 6144
  s_add_u32 s57, s45, 16384
  v_mfma_f32_16x16x32_bf16 v[144:147], a[20:23], a[8:11], v[144:147]
  ds_read_b128 a[44:47], v36 offset:0
  buffer_load_dwordx4 v87, s[24:27], s57 offen lds
  v_add_u32 v37, s63, v29
  v_mfma_f32_16x16x32_bf16 v[168:171], a[20:23], a[12:15], v[168:171]
  ds_read_b128 a[48:51], v36 offset:2048
  v_mfma_f32_16x16x32_bf16 v[100:103], a[24:27], a[0:3], v[100:103]
  s_add_u32 m0, s96, 7168
  s_add_u32 s57, s45, 24576
  v_mfma_f32_16x16x32_bf16 v[124:127], a[24:27], a[4:7], v[124:127]
  ds_read_b128 a[52:55], v36 offset:4096
  buffer_load_dwordx4 v87, s[24:27], s57 offen lds
  v_add_u32 v38, s63, v30
  v_mfma_f32_16x16x32_bf16 v[148:151], a[24:27], a[8:11], v[148:151]
  ds_read_b128 a[56:59], v36 offset:6144
  v_mfma_f32_16x16x32_bf16 v[172:175], a[24:27], a[12:15], v[172:175]
  ds_read_b64_tr_b16 a[68:69], v209 offset:4096
  v_add_u32 v39, s63, v31
  v_mfma_f32_16x16x32_bf16 v[104:107], a[28:31], a[0:3], v[104:107]
  ds_read_b64_tr_b16 a[70:71], v209 offset:4608
  s_lshl_b32 s45, s44, 15
  s_add_u32 s44, s44, 1
  s_cmp_eq_u32 s44, s15
  s_cselect_b32 s44, 0, s44
  s_add_u32 m0, s96, 8192
  s_add_u32 s57, s45, 0
  v_mfma_f32_16x16x32_bf16 v[128:131], a[28:31], a[4:7], v[128:131]
  buffer_load_dwordx4 v87, s[24:27], s57 offen lds
  v_mfma_f32_16x16x32_bf16 v[152:155], a[28:31], a[8:11], v[152:155]
  ds_read_b64_tr_b16 a[72:73], v210 offset:4096
  v_add_u32 v40, s63, v32
  v_mfma_f32_16x16x32_bf16 v[176:179], a[28:31], a[12:15], v[176:179]
  ds_read_b64_tr_b16 a[74:75], v210 offset:4608
  v_mfma_f32_16x16x32_bf16 v[108:111], a[32:35], a[0:3], v[108:111]
  ds_read_b64_tr_b16 a[76:77], v211 offset:4096
  s_add_u32 m0, s96, 9216
  s_add_u32 s57, s45, 8192
  v_add_u32 v41, s63, v33
  v_mfma_f32_16x16x32_bf16 v[132:135], a[32:35], a[4:7], v[132:135]
  ds_read_b64_tr_b16 a[78:79], v211 offset:4608
  buffer_load_dwordx4 v87, s[24:27], s57 offen lds
  v_mfma_f32_16x16x32_bf16 v[156:159], a[32:35], a[8:11], v[156:159]
  v_mfma_f32_16x16x32_bf16 v[180:183], a[32:35], a[12:15], v[180:183]
  ds_read_b64_tr_b16 a[80:81], v212 offset:4096
  s_add_u32 m0, s96, 10240
  s_add_u32 s57, s45, 16384
  v_add_u32 v42, s63, v34
  v_mfma_f32_16x16x32_bf16 v[112:115], a[36:39], a[0:3], v[112:115]
  ds_read_b64_tr_b16 a[82:83], v212 offset:4608
  buffer_load_dwordx4 v87, s[24:27], s57 offen lds
  v_mfma_f32_16x16x32_bf16 v[136:139], a[36:39], a[4:7], v[136:139]
  ds_read_b64_tr_b16 a[84:85], v213 offset:4096
  v_mfma_f32_16x16x32_bf16 v[160:163], a[36:39], a[8:11], v[160:163]
  ds_read_b64_tr_b16 a[86:87], v213 offset:4608
  v_mfma_f32_16x16x32_bf16 v[184:187], a[36:39], a[12:15], v[184:187]
  s_add_u32 m0, s96, 11264
  s_add_u32 s57, s45, 24576
  v_mfma_f32_16x16x32_bf16 v[116:119], a[40:43], a[0:3], v[116:119]
  buffer_load_dwordx4 v87, s[24:27], s57 offen lds
  v_mfma_f32_16x16x32_bf16 v[140:143], a[40:43], a[4:7], v[140:143]
  v_mfma_f32_16x16x32_bf16 v[164:167], a[40:43], a[8:11], v[164:167]
  v_mfma_f32_16x16x32_bf16 v[188:191], a[40:43], a[12:15], v[188:191]
  s_waitcnt vmcnt(12) lgkmcnt(0)
  s_barrier
  v_mfma_f32_16x16x32_bf16 v[96:99], a[64:67], a[44:47], v[96:99]
  ds_read_b64_tr_b16 a[20:21], v37 offset:0
  v_add_u32 v36, s63, v28
  v_mfma_f32_16x16x32_bf16 v[120:123], a[64:67], a[48:51], v[120:123]
  ds_read_b64_tr_b16 a[22:23], v37 offset:512
  s_lshl_b32 s45, s44, 15
  s_add_u32 s44, s44, 1
  s_cmp_eq_u32 s44, s15
  s_cselect_b32 s44, 0, s44
  s_add_u32 m0, s96, 12288
  s_add_u32 s57, s45, 0
  v_mfma_f32_16x16x32_bf16 v[144:147], a[64:67], a[52:55], v[144:147]
  ds_read_b128 a[0:3], v35 offset:0
  buffer_load_dwordx4 v87, s[24:27], s57 offen lds
  v_add_u32 v208, s63, v29
  v_mfma_f32_16x16x32_bf16 v[168:171], a[64:67], a[56:59], v[168:171]
  ds_read_b128 a[4:7], v35 offset:2048
  v_mfma_f32_16x16x32_bf16 v[100:103], a[68:71], a[44:47], v[100:103]
  s_add_u32 m0, s96, 13312
  s_add_u32 s57, s45, 8192
  v_mfma_f32_16x16x32_bf16 v[124:127], a[68:71], a[48:51], v[124:127]
  ds_read_b128 a[8:11], v35 offset:4096
  buffer_load_dwordx4 v87, s[24:27], s57 offen lds
  v_add_u32 v209, s63, v30
  v_mfma_f32_16x16x32_bf16 v[148:151], a[68:71], a[52:55], v[148:151]
  ds_read_b128 a[12:15], v35 offset:6144
  v_mfma_f32_16x16x32_bf16 v[172:175], a[68:71], a[56:59], v[172:175]
  ds_read_b64_tr_b16 a[24:25], v38 offset:0
  v_mfma_f32_16x16x32_bf16 v[104:107], a[72:75], a[44:47], v[104:107]
  ds_read_b64_tr_b16 a[26:27], v38 offset:512
  s_add_u32 m0, s96, 14336
  s_add_u32 s57, s45, 16384
  v_add_u32 v210, s63, v31
  v_mfma_f32_16x16x32_bf16 v[128:131], a[72:75], a[48:51], v[128:131]
  buffer_load_dwordx4 v87, s[24:27], s57 offen lds
  v_mfma_f32_16x16x32_bf16 v[152:155], a[72:75], a[52:55], v[152:155]
  ds_read_b64_tr_b16 a[28:29], v39 offset:0
  v_mfma_f32_16x16x32_bf16 v[176:179], a[72:75], a[56:59], v[176:179]
  ds_read_b64_tr_b16 a[30:31], v39 offset:512
  v_add_u32 v211, s63, v32
  v_mfma_f32_16x16x32_bf16 v[108:111], a[76:79], a[44:47], v[108:111]
  ds_read_b64_tr_b16 a[32:33], v40 offset:0
  s_add_u32 m0, s96, 15360
  s_add_u32 s57, s45, 24576
  v_mfma_f32_16x16x32_bf16 v[132:135], a[76:79], a[48:51], v[132:135]
  ds_read_b64_tr_b16 a[34:35], v40 offset:512
  buffer_load_dwordx4 v87, s[24:27], s57 offen lds
  v_mfma_f32_16x16x32_bf16 v[156:159], a[76:79], a[52:55], v[156:159]
  v_add_u32 v212, s63, v33
  v_mfma_f32_16x16x32_bf16 v[180:183], a[76:79], a[56:59], v[180:183]
  ds_read_b64_tr_b16 a[36:37], v41 offset:0
  s_lshl_b32 s45, s44, 15
  s_add_u32 s44, s44, 1
  s_cmp_eq_u32 s44, s15
  s_cselect_b32 s44, 0, s44
  s_add_u32 m0, s97, 0
  s_add_u32 s57, s45, 0
  v_mfma_f32_16x16x32_bf16 v[112:115], a[80:83], a[44:47], v[112:115]
  ds_read_b64_tr_b16 a[38:39], v41 offset:512
  buffer_load_dwordx4 v87, s[24:27], s57 offen lds
  v_mfma_f32_16x16x32_bf16 v[136:139], a[80:83], a[48:51], v[136:139]
  ds_read_b64_tr_b16 a[40:41], v42 offset:0
  v_add_u32 v213, s63, v34
  v_mfma_f32_16x16x32_bf16 v[160:163], a[80:83], a[52:55], v[160:163]
  ds_read_b64_tr_b16 a[42:43], v42 offset:512
  v_mfma_f32_16x16x32_bf16 v[184:187], a[80:83], a[56:59], v[184:187]
  s_add_u32 m0, s97, 1024
  s_add_u32 s57, s45, 8192
  v_mfma_f32_16x16x32_bf16 v[116:119], a[84:87], a[44:47], v[116:119]
  buffer_load_dwordx4 v87, s[24:27], s57 offen lds
  v_mfma_f32_16x16x32_bf16 v[140:143], a[84:87], a[48:51], v[140:143]
  s_mov_b32 s65, s55
  s_mov_b32 s55, s54
  v_mfma_f32_16x16x32_bf16 v[164:167], a[84:87], a[52:55], v[164:167]
  s_mov_b32 s54, s63
  s_mov_b32 s63, s65
  v_mfma_f32_16x16x32_bf16 v[188:191], a[84:87], a[56:59], v[188:191]
  s_waitcnt lgkmcnt(0)
  v_mfma_f32_16x16x32_bf16 v[96:99], a[20:23], a[0:3], v[96:99]
  ds_read_b64_tr_b16 a[64:65], v208 offset:4096
  v_mfma_f32_16x16x32_bf16 v[120:123], a[20:23], a[4:7], v[120:123]
  ds_read_b64_tr_b16 a[66:67], v208 offset:4608
  s_add_u32 m0, s97, 2048
  s_add_u32 s57, s45, 16384
  v_mfma_f32_16x16x32_bf16 v[144:147], a[20:23], a[8:11], v[144:147]
  ds_read_b128 a[44:47], v36 offset:0
  buffer_load_dwordx4 v87, s[24:27], s57 offen lds
  v_mfma_f32_16x16x32_bf16 v[168:171], a[20:23], a[12:15], v[168:171]
  ds_read_b128 a[48:51], v36 offset:2048
  v_mfma_f32_16x16x32_bf16 v[100:103], a[24:27], a[0:3], v[100:103]
  s_add_u32 m0, s97, 3072
  s_add_u32 s57, s45, 24576
  v_mfma_f32_16x16x32_bf16 v[124:127], a[24:27], a[4:7], v[124:127]
  ds_read_b128 a[52:55], v36 offset:4096
  buffer_load_dwordx4 v87, s[24:27], s57 offen lds
  v_mfma_f32_16x16x32_bf16 v[148:151], a[24:27], a[8:11], v[148:151]
  ds_read_b128 a[56:59], v36 offset:6144
  v_mfma_f32_16x16x32_bf16 v[172:175], a[24:27], a[12:15], v[172:175]
  ds_read_b64_tr_b16 a[68:69], v209 offset:4096
  v_mfma_f32_16x16x32_bf16 v[104:107], a[28:31], a[0:3], v[104:107]
  ds_read_b64_tr_b16 a[70:71], v209 offset:4608
  s_lshl_b32 s45, s44, 15
  s_add_u32 s44, s44, 1
  s_cmp_eq_u32 s44, s15
  s_cselect_b32 s44, 0, s44
  s_add_u32 m0, s97, 4096
  s_add_u32 s57, s45, 0
  v_mfma_f32_16x16x32_bf16 v[128:131], a[28:31], a[4:7], v[128:131]
  buffer_load_dwordx4 v87, s[24:27], s57 offen lds
  v_mfma_f32_16x16x32_bf16 v[152:155], a[28:31], a[8:11], v[152:155]
  ds_read_b64_tr_b16 a[72:73], v210 offset:4096
  v_mfma_f32_16x16x32_bf16 v[176:179], a[28:31], a[12:15], v[176:179]
  ds_read_b64_tr_b16 a[74:75], v210 offset:4608
  v_mfma_f32_16x16x32_bf16 v[108:111], a[32:35], a[0:3], v[108:111]
  ds_read_b64_tr_b16 a[76:77], v211 offset:4096
  s_add_u32 m0, s97, 5120
  s_add_u32 s57, s45, 8192
  v_mfma_f32_16x16x32_bf16 v[132:135], a[32:35], a[4:7], v[132:135]
  ds_read_b64_tr_b16 a[78:79], v211 offset:4608
  buffer_load_dwordx4 v87, s[24:27], s57 offen lds
  v_mfma_f32_16x16x32_bf16 v[156:159], a[32:35], a[8:11], v[156:159]
  v_mfma_f32_16x16x32_bf16 v[180:183], a[32:35], a[12:15], v[180:183]
  ds_read_b64_tr_b16 a[80:81], v212 offset:4096
  s_add_u32 m0, s97, 6144
  s_add_u32 s57, s45, 16384
  v_mfma_f32_16x16x32_bf16 v[112:115], a[36:39], a[0:3], v[112:115]
  ds_read_b64_tr_b16 a[82:83], v212 offset:4608
  buffer_load_dwordx4 v87, s[24:27], s57 offen lds
  v_mfma_f32_16x16x32_bf16 v[136:139], a[36:39], a[4:7], v[136:139]
  ds_read_b64_tr_b16 a[84:85], v213 offset:4096
  v_mfma_f32_16x16x32_bf16 v[160:163], a[36:39], a[8:11], v[160:163]
  ds_read_b64_tr_b16 a[86:87], v213 offset:4608
  v_mfma_f32_16x16x32_bf16 v[184:187], a[36:39], a[12:15], v[184:187]
  s_add_u32 m0, s97, 7168
  s_add_u32 s57, s45, 24576
  v_mfma_f32_16x16x32_bf16 v[116:119], a[40:43], a[0:3], v[116:119]
  buffer_load_dwordx4 v87, s[24:27], s57 offen lds
  v_mfma_f32_16x16x32_bf16 v[140:143], a[40:43], a[4:7], v[140:143]
  v_mfma_f32_16x16x32_bf16 v[164:167], a[40:43], a[8:11], v[164:167]
  v_mfma_f32_16x16x32_bf16 v[188:191], a[40:43], a[12:15], v[188:191]
  s_waitcnt lgkmcnt(0)
  s_barrier
  v_mfma_f32_16x16x32_bf16 v[96:99], a[64:67], a[44:47], v[96:99]
  v_mfma_f32_16x16x32_bf16 v[120:123], a[64:67], a[48:51], v[120:123]
  s_lshl_b32 s45, s44, 15
  s_add_u32 s44, s44, 1
  s_cmp_eq_u32 s44, s15
  s_cselect_b32 s44, 0, s44
  s_add_u32 m0, s98, 0
  s_add_u32 s57, s45, 0
  v_mfma_f32_16x16x32_bf16 v[144:147], a[64:67], a[52:55], v[144:147]
  buffer_load_dwordx4 v87, s[24:27], s57 offen lds
  v_mfma_f32_16x16x32_bf16 v[168:171], a[64:67], a[56:59], v[168:171]
  s_add_u32 m0, s98, 1024
  s_add_u32 s57, s45, 8192
  v_mfma_f32_16x16x32_bf16 v[100:103], a[68:71], a[44:47], v[100:103]
  buffer_load_dwordx4 v87, s[24:27], s57 offen lds
  v_mfma_f32_16x16x32_bf16 v[124:127], a[68:71], a[48:51], v[124:127]
  v_mfma_f32_16x16x32_bf16 v[148:151], a[68:71], a[52:55], v[148:151]
  s_add_u32 m0, s98, 2048
  s_add_u32 s57, s45, 16384
  v_mfma_f32_16x16x32_bf16 v[172:175], a[68:71], a[56:59], v[172:175]
  buffer_load_dwordx4 v87, s[24:27], s57 offen lds
  v_mfma_f32_16x16x32_bf16 v[104:107], a[72:75], a[44:47], v[104:107]
  v_mfma_f32_16x16x32_bf16 v[128:131], a[72:75], a[48:51], v[128:131]
  s_add_u32 m0, s98, 3072
  s_add_u32 s57, s45, 24576
  v_mfma_f32_16x16x32_bf16 v[152:155], a[72:75], a[52:55], v[152:155]
  buffer_load_dwordx4 v87, s[24:27], s57 offen lds
  v_mfma_f32_16x16x32_bf16 v[176:179], a[72:75], a[56:59], v[176:179]
  v_mfma_f32_16x16x32_bf16 v[108:111], a[76:79], a[44:47], v[108:111]
  s_lshl_b32 s45, s44, 15
  s_add_u32 s44, s44, 1
  s_cmp_eq_u32 s44, s15
  s_cselect_b32 s44, 0, s44
  s_add_u32 m0, s99, 0
  s_add_u32 s57, s45, 0
  v_mfma_f32_16x16x32_bf16 v[132:135], a[76:79], a[48:51], v[132:135]
  buffer_load_dwordx4 v87, s[24:27], s57 offen lds
  v_mfma_f32_16x16x32_bf16 v[156:159], a[76:79], a[52:55], v[156:159]
  s_add_u32 m0, s99, 1024
  s_add_u32 s57, s45, 8192
  v_mfma_f32_16x16x32_bf16 v[180:183], a[76:79], a[56:59], v[180:183]
  buffer_load_dwordx4 v87, s[24:27], s57 offen lds
  v_mfma_f32_16x16x32_bf16 v[112:115], a[80:83], a[44:47], v[112:115]
  v_mfma_f32_16x16x32_bf16 v[136:139], a[80:83], a[48:51], v[136:139]
  s_add_u32 m0, s99, 2048
  s_add_u32 s57, s45, 16384
  v_mfma_f32_16x16x32_bf16 v[160:163], a[80:83], a[52:55], v[160:163]
  buffer_load_dwordx4 v87, s[24:27], s57 offen lds
  v_mfma_f32_16x16x32_bf16 v[184:187], a[80:83], a[56:59], v[184:187]
  v_mfma_f32_16x16x32_bf16 v[116:119], a[84:87], a[44:47], v[116:119]
  s_add_u32 m0, s99, 3072
  s_add_u32 s57, s45, 24576
  v_mfma_f32_16x16x32_bf16 v[140:143], a[84:87], a[48:51], v[140:143]
  buffer_load_dwordx4 v87, s[24:27], s57 offen lds
  v_mfma_f32_16x16x32_bf16 v[164:167], a[84:87], a[52:55], v[164:167]
  v_mfma_f32_16x16x32_bf16 v[188:191], a[84:87], a[56:59], v[188:191]
  global_load_dword v64, v43, s[50:51] sc1
  s_nop 7
  v_pk_mul_f32 v[16:17], v[96:97], s[0:1] op_sel_hi:[1,0]
  s_lshl_b32 s45, s44, 15
  s_add_u32 s44, s44, 1
  s_cmp_eq_u32 s44, s15
  s_cselect_b32 s44, 0, s44
  s_add_u32 m0, s100, 0
  s_add_u32 s57, s45, 0
  v_pk_mul_f32 v[18:19], v[98:99], s[0:1] op_sel_hi:[1,0]
  v_pk_mul_f32 v[20:21], v[100:101], s[0:1] op_sel_hi:[1,0]
  buffer_load_dwordx4 v87, s[24:27], s57 offen lds
  v_pk_mul_f32 v[22:23], v[102:103], s[0:1] op_sel_hi:[1,0]
  v_exp_f32 v16, v16
  v_exp_f32 v17, v17
  v_exp_f32 v18, v18
  v_exp_f32 v19, v19
  s_add_u32 m0, s100, 1024
  s_add_u32 s57, s45, 8192
  v_exp_f32 v20, v20
  v_exp_f32 v21, v21
  buffer_load_dwordx4 v87, s[24:27], s57 offen lds
  v_exp_f32 v22, v22
  v_exp_f32 v23, v23
  v_pk_fma_f32 v[24:25], v[16:17], 0.5, 1.0 op_sel_hi:[1,0,0]
  v_pk_fma_f32 v[26:27], v[18:19], 0.5, 1.0 op_sel_hi:[1,0,0]
  v_pk_fma_f32 v[28:29], v[20:21], 0.5, 1.0 op_sel_hi:[1,0,0]
  s_add_u32 m0, s100, 2048
  s_add_u32 s57, s45, 16384
  v_pk_fma_f32 v[30:31], v[22:23], 0.5, 1.0 op_sel_hi:[1,0,0]
  v_pk_fma_f32 v[24:25], v[24:25], v[16:17], 1.0 op_sel_hi:[1,1,0]
  buffer_load_dwordx4 v87, s[24:27], s57 offen lds
  v_pk_fma_f32 v[26:27], v[26:27], v[18:19], 1.0 op_sel_hi:[1,1,0]
  v_pk_fma_f32 v[28:29], v[28:29], v[20:21], 1.0 op_sel_hi:[1,1,0]
  v_pk_fma_f32 v[30:31], v[30:31], v[22:23], 1.0 op_sel_hi:[1,1,0]
  v_rcp_f32 v24, v24
  v_rcp_f32 v25, v25
  s_add_u32 m0, s100, 3072
  s_add_u32 s57, s45, 24576
  v_rcp_f32 v26, v26
  v_rcp_f32 v27, v27
  buffer_load_dwordx4 v87, s[24:27], s57 offen lds
  v_rcp_f32 v28, v28
  v_rcp_f32 v29, v29
  v_rcp_f32 v30, v30
  v_rcp_f32 v31, v31
  v_pk_fma_f32 v[96:97], v[96:97], v[24:25], v[96:97] neg_lo:[1,0,0] neg_hi:[1,0,0]
  v_pk_fma_f32 v[98:99], v[98:99], v[26:27], v[98:99] neg_lo:[1,0,0] neg_hi:[1,0,0]
  v_pk_fma_f32 v[100:101], v[100:101], v[28:29], v[100:101] neg_lo:[1,0,0] neg_hi:[1,0,0]
  v_pk_fma_f32 v[102:103], v[102:103], v[30:31], v[102:103] neg_lo:[1,0,0] neg_hi:[1,0,0]
  v_cvt_pk_bf16_f32 v32, v96, v97
  v_cvt_pk_bf16_f32 v33, v98, v99
  v_cvt_pk_bf16_f32 v34, v100, v101
  v_cvt_pk_bf16_f32 v35, v102, v103
  buffer_store_dwordx4 v[32:35], v250, s[32:35], s71 offen offset:0 sc1
  v_pk_mul_f32 v[16:17], v[120:121], s[0:1] op_sel_hi:[1,0]
  v_pk_mul_f32 v[18:19], v[122:123], s[0:1] op_sel_hi:[1,0]
  v_pk_mul_f32 v[20:21], v[124:125], s[0:1] op_sel_hi:[1,0]
  v_pk_mul_f32 v[22:23], v[126:127], s[0:1] op_sel_hi:[1,0]
  v_exp_f32 v16, v16
  v_exp_f32 v17, v17
  v_exp_f32 v18, v18
  v_exp_f32 v19, v19
  v_exp_f32 v20, v20
  v_exp_f32 v21, v21
  v_exp_f32 v22, v22
  v_exp_f32 v23, v23
  v_pk_fma_f32 v[24:25], v[16:17], 0.5, 1.0 op_sel_hi:[1,0,0]
  v_pk_fma_f32 v[26:27], v[18:19], 0.5, 1.0 op_sel_hi:[1,0,0]
  v_pk_fma_f32 v[28:29], v[20:21], 0.5, 1.0 op_sel_hi:[1,0,0]
  v_pk_fma_f32 v[30:31], v[22:23], 0.5, 1.0 op_sel_hi:[1,0,0]
  v_pk_fma_f32 v[24:25], v[24:25], v[16:17], 1.0 op_sel_hi:[1,1,0]
  v_pk_fma_f32 v[26:27], v[26:27], v[18:19], 1.0 op_sel_hi:[1,1,0]
  v_pk_fma_f32 v[28:29], v[28:29], v[20:21], 1.0 op_sel_hi:[1,1,0]
  v_pk_fma_f32 v[30:31], v[30:31], v[22:23], 1.0 op_sel_hi:[1,1,0]
  v_rcp_f32 v24, v24
  v_rcp_f32 v25, v25
  v_rcp_f32 v26, v26
  v_rcp_f32 v27, v27
  v_rcp_f32 v28, v28
  v_rcp_f32 v29, v29
  v_rcp_f32 v30, v30
  v_rcp_f32 v31, v31
  v_pk_fma_f32 v[120:121], v[120:121], v[24:25], v[120:121] neg_lo:[1,0,0] neg_hi:[1,0,0]
  v_pk_fma_f32 v[122:123], v[122:123], v[26:27], v[122:123] neg_lo:[1,0,0] neg_hi:[1,0,0]
  v_pk_fma_f32 v[124:125], v[124:125], v[28:29], v[124:125] neg_lo:[1,0,0] neg_hi:[1,0,0]
  v_pk_fma_f32 v[126:127], v[126:127], v[30:31], v[126:127] neg_lo:[1,0,0] neg_hi:[1,0,0]
  v_cvt_pk_bf16_f32 v36, v120, v121
  v_cvt_pk_bf16_f32 v37, v122, v123
  v_cvt_pk_bf16_f32 v38, v124, v125
  v_cvt_pk_bf16_f32 v39, v126, v127
  buffer_store_dwordx4 v[36:39], v250, s[32:35], s71 offen offset:1024 sc1
  v_pk_mul_f32 v[16:17], v[144:145], s[0:1] op_sel_hi:[1,0]
  v_pk_mul_f32 v[18:19], v[146:147], s[0:1] op_sel_hi:[1,0]
  v_pk_mul_f32 v[20:21], v[148:149], s[0:1] op_sel_hi:[1,0]
  v_pk_mul_f32 v[22:23], v[150:151], s[0:1] op_sel_hi:[1,0]
  v_exp_f32 v16, v16
  v_exp_f32 v17, v17
  v_exp_f32 v18, v18
  v_exp_f32 v19, v19
  v_exp_f32 v20, v20
  v_exp_f32 v21, v21
  v_exp_f32 v22, v22
  v_exp_f32 v23, v23
  v_pk_fma_f32 v[24:25], v[16:17], 0.5, 1.0 op_sel_hi:[1,0,0]
  v_pk_fma_f32 v[26:27], v[18:19], 0.5, 1.0 op_sel_hi:[1,0,0]
  v_pk_fma_f32 v[28:29], v[20:21], 0.5, 1.0 op_sel_hi:[1,0,0]
  v_pk_fma_f32 v[30:31], v[22:23], 0.5, 1.0 op_sel_hi:[1,0,0]
  v_pk_fma_f32 v[24:25], v[24:25], v[16:17], 1.0 op_sel_hi:[1,1,0]
  v_pk_fma_f32 v[26:27], v[26:27], v[18:19], 1.0 op_sel_hi:[1,1,0]
  v_pk_fma_f32 v[28:29], v[28:29], v[20:21], 1.0 op_sel_hi:[1,1,0]
  v_pk_fma_f32 v[30:31], v[30:31], v[22:23], 1.0 op_sel_hi:[1,1,0]
  v_rcp_f32 v24, v24
  v_rcp_f32 v25, v25
  v_rcp_f32 v26, v26
  v_rcp_f32 v27, v27
  v_rcp_f32 v28, v28
  v_rcp_f32 v29, v29
  v_rcp_f32 v30, v30
  v_rcp_f32 v31, v31
  v_pk_fma_f32 v[144:145], v[144:145], v[24:25], v[144:145] neg_lo:[1,0,0] neg_hi:[1,0,0]
  v_pk_fma_f32 v[146:147], v[146:147], v[26:27], v[146:147] neg_lo:[1,0,0] neg_hi:[1,0,0]
  v_pk_fma_f32 v[148:149], v[148:149], v[28:29], v[148:149] neg_lo:[1,0,0] neg_hi:[1,0,0]
  v_pk_fma_f32 v[150:151], v[150:151], v[30:31], v[150:151] neg_lo:[1,0,0] neg_hi:[1,0,0]
  v_cvt_pk_bf16_f32 v32, v144, v145
  v_cvt_pk_bf16_f32 v33, v146, v147
  v_cvt_pk_bf16_f32 v34, v148, v149
  v_cvt_pk_bf16_f32 v35, v150, v151
  buffer_store_dwordx4 v[32:35], v250, s[32:35], s71 offen offset:2048 sc1
  v_pk_mul_f32 v[16:17], v[168:169], s[0:1] op_sel_hi:[1,0]
  v_pk_mul_f32 v[18:19], v[170:171], s[0:1] op_sel_hi:[1,0]
  v_pk_mul_f32 v[20:21], v[172:173], s[0:1] op_sel_hi:[1,0]
  v_pk_mul_f32 v[22:23], v[174:175], s[0:1] op_sel_hi:[1,0]
  v_exp_f32 v16, v16
  v_exp_f32 v17, v17
  v_exp_f32 v18, v18
  v_exp_f32 v19, v19
  v_exp_f32 v20, v20
  v_exp_f32 v21, v21
  v_exp_f32 v22, v22
  v_exp_f32 v23, v23
  v_pk_fma_f32 v[24:25], v[16:17], 0.5, 1.0 op_sel_hi:[1,0,0]
  v_pk_fma_f32 v[26:27], v[18:19], 0.5, 1.0 op_sel_hi:[1,0,0]
  v_pk_fma_f32 v[28:29], v[20:21], 0.5, 1.0 op_sel_hi:[1,0,0]
  v_pk_fma_f32 v[30:31], v[22:23], 0.5, 1.0 op_sel_hi:[1,0,0]
  v_pk_fma_f32 v[24:25], v[24:25], v[16:17], 1.0 op_sel_hi:[1,1,0]
  v_pk_fma_f32 v[26:27], v[26:27], v[18:19], 1.0 op_sel_hi:[1,1,0]
  v_pk_fma_f32 v[28:29], v[28:29], v[20:21], 1.0 op_sel_hi:[1,1,0]
  v_pk_fma_f32 v[30:31], v[30:31], v[22:23], 1.0 op_sel_hi:[1,1,0]
  v_rcp_f32 v24, v24
  v_rcp_f32 v25, v25
  v_rcp_f32 v26, v26
  v_rcp_f32 v27, v27
  v_rcp_f32 v28, v28
  v_rcp_f32 v29, v29
  v_rcp_f32 v30, v30
  v_rcp_f32 v31, v31
  v_pk_fma_f32 v[168:169], v[168:169], v[24:25], v[168:169] neg_lo:[1,0,0] neg_hi:[1,0,0]
  v_pk_fma_f32 v[170:171], v[170:171], v[26:27], v[170:171] neg_lo:[1,0,0] neg_hi:[1,0,0]
  v_pk_fma_f32 v[172:173], v[172:173], v[28:29], v[172:173] neg_lo:[1,0,0] neg_hi:[1,0,0]
  v_pk_fma_f32 v[174:175], v[174:175], v[30:31], v[174:175] neg_lo:[1,0,0] neg_hi:[1,0,0]
  v_cvt_pk_bf16_f32 v36, v168, v169
  v_cvt_pk_bf16_f32 v37, v170, v171
  v_cvt_pk_bf16_f32 v38, v172, v173
  v_cvt_pk_bf16_f32 v39, v174, v175
  buffer_store_dwordx4 v[36:39], v250, s[32:35], s71 offen offset:3072 sc1
  s_add_u32 s71, s71, 131072
  v_pk_mul_f32 v[16:17], v[104:105], s[0:1] op_sel_hi:[1,0]
  v_pk_mul_f32 v[18:19], v[106:107], s[0:1] op_sel_hi:[1,0]
  v_pk_mul_f32 v[20:21], v[108:109], s[0:1] op_sel_hi:[1,0]
  v_pk_mul_f32 v[22:23], v[110:111], s[0:1] op_sel_hi:[1,0]
  v_exp_f32 v16, v16
  v_exp_f32 v17, v17
  v_exp_f32 v18, v18
  v_exp_f32 v19, v19
  v_exp_f32 v20, v20
  v_exp_f32 v21, v21
  v_exp_f32 v22, v22
  v_exp_f32 v23, v23
  v_pk_fma_f32 v[24:25], v[16:17], 0.5, 1.0 op_sel_hi:[1,0,0]
  v_pk_fma_f32 v[26:27], v[18:19], 0.5, 1.0 op_sel_hi:[1,0,0]
  v_pk_fma_f32 v[28:29], v[20:21], 0.5, 1.0 op_sel_hi:[1,0,0]
  v_pk_fma_f32 v[30:31], v[22:23], 0.5, 1.0 op_sel_hi:[1,0,0]
  v_pk_fma_f32 v[24:25], v[24:25], v[16:17], 1.0 op_sel_hi:[1,1,0]
  v_pk_fma_f32 v[26:27], v[26:27], v[18:19], 1.0 op_sel_hi:[1,1,0]
  v_pk_fma_f32 v[28:29], v[28:29], v[20:21], 1.0 op_sel_hi:[1,1,0]
  v_pk_fma_f32 v[30:31], v[30:31], v[22:23], 1.0 op_sel_hi:[1,1,0]
  v_rcp_f32 v24, v24
  v_rcp_f32 v25, v25
  v_rcp_f32 v26, v26
  v_rcp_f32 v27, v27
  v_rcp_f32 v28, v28
  v_rcp_f32 v29, v29
  v_rcp_f32 v30, v30
  v_rcp_f32 v31, v31
  v_pk_fma_f32 v[104:105], v[104:105], v[24:25], v[104:105] neg_lo:[1,0,0] neg_hi:[1,0,0]
  v_pk_fma_f32 v[106:107], v[106:107], v[26:27], v[106:107] neg_lo:[1,0,0] neg_hi:[1,0,0]
  v_pk_fma_f32 v[108:109], v[108:109], v[28:29], v[108:109] neg_lo:[1,0,0] neg_hi:[1,0,0]
  v_pk_fma_f32 v[110:111], v[110:111], v[30:31], v[110:111] neg_lo:[1,0,0] neg_hi:[1,0,0]
  v_cvt_pk_bf16_f32 v32, v104, v105
  v_cvt_pk_bf16_f32 v33, v106, v107
  v_cvt_pk_bf16_f32 v34, v108, v109
  v_cvt_pk_bf16_f32 v35, v110, v111
  buffer_store_dwordx4 v[32:35], v250, s[32:35], s71 offen offset:0 sc1
  v_pk_mul_f32 v[16:17], v[128:129], s[0:1] op_sel_hi:[1,0]
  v_pk_mul_f32 v[18:19], v[130:131], s[0:1] op_sel_hi:[1,0]
  v_pk_mul_f32 v[20:21], v[132:133], s[0:1] op_sel_hi:[1,0]
  v_pk_mul_f32 v[22:23], v[134:135], s[0:1] op_sel_hi:[1,0]
  v_exp_f32 v16, v16
  v_exp_f32 v17, v17
  v_exp_f32 v18, v18
  v_exp_f32 v19, v19
  v_exp_f32 v20, v20
  v_exp_f32 v21, v21
  v_exp_f32 v22, v22
  v_exp_f32 v23, v23
  v_pk_fma_f32 v[24:25], v[16:17], 0.5, 1.0 op_sel_hi:[1,0,0]
  v_pk_fma_f32 v[26:27], v[18:19], 0.5, 1.0 op_sel_hi:[1,0,0]
  v_pk_fma_f32 v[28:29], v[20:21], 0.5, 1.0 op_sel_hi:[1,0,0]
  v_pk_fma_f32 v[30:31], v[22:23], 0.5, 1.0 op_sel_hi:[1,0,0]
  v_pk_fma_f32 v[24:25], v[24:25], v[16:17], 1.0 op_sel_hi:[1,1,0]
  v_pk_fma_f32 v[26:27], v[26:27], v[18:19], 1.0 op_sel_hi:[1,1,0]
  v_pk_fma_f32 v[28:29], v[28:29], v[20:21], 1.0 op_sel_hi:[1,1,0]
  v_pk_fma_f32 v[30:31], v[30:31], v[22:23], 1.0 op_sel_hi:[1,1,0]
  v_rcp_f32 v24, v24
  v_rcp_f32 v25, v25
  v_rcp_f32 v26, v26
  v_rcp_f32 v27, v27
  v_rcp_f32 v28, v28
  v_rcp_f32 v29, v29
  v_rcp_f32 v30, v30
  v_rcp_f32 v31, v31
  v_pk_fma_f32 v[128:129], v[128:129], v[24:25], v[128:129] neg_lo:[1,0,0] neg_hi:[1,0,0]
  v_pk_fma_f32 v[130:131], v[130:131], v[26:27], v[130:131] neg_lo:[1,0,0] neg_hi:[1,0,0]
  v_pk_fma_f32 v[132:133], v[132:133], v[28:29], v[132:133] neg_lo:[1,0,0] neg_hi:[1,0,0]
  v_pk_fma_f32 v[134:135], v[134:135], v[30:31], v[134:135] neg_lo:[1,0,0] neg_hi:[1,0,0]
  v_cvt_pk_bf16_f32 v36, v128, v129
  v_cvt_pk_bf16_f32 v37, v130, v131
  v_cvt_pk_bf16_f32 v38, v132, v133
  v_cvt_pk_bf16_f32 v39, v134, v135
  buffer_store_dwordx4 v[36:39], v250, s[32:35], s71 offen offset:1024 sc1
  v_pk_mul_f32 v[16:17], v[152:153], s[0:1] op_sel_hi:[1,0]
  v_pk_mul_f32 v[18:19], v[154:155], s[0:1] op_sel_hi:[1,0]
  v_pk_mul_f32 v[20:21], v[156:157], s[0:1] op_sel_hi:[1,0]
  v_pk_mul_f32 v[22:23], v[158:159], s[0:1] op_sel_hi:[1,0]
  v_exp_f32 v16, v16
  v_exp_f32 v17, v17
  v_exp_f32 v18, v18
  v_exp_f32 v19, v19
  v_exp_f32 v20, v20
  v_exp_f32 v21, v21
  v_exp_f32 v22, v22
  v_exp_f32 v23, v23
  v_pk_fma_f32 v[24:25], v[16:17], 0.5, 1.0 op_sel_hi:[1,0,0]
  v_pk_fma_f32 v[26:27], v[18:19], 0.5, 1.0 op_sel_hi:[1,0,0]
  v_pk_fma_f32 v[28:29], v[20:21], 0.5, 1.0 op_sel_hi:[1,0,0]
  v_pk_fma_f32 v[30:31], v[22:23], 0.5, 1.0 op_sel_hi:[1,0,0]
  v_pk_fma_f32 v[24:25], v[24:25], v[16:17], 1.0 op_sel_hi:[1,1,0]
  v_pk_fma_f32 v[26:27], v[26:27], v[18:19], 1.0 op_sel_hi:[1,1,0]
  v_pk_fma_f32 v[28:29], v[28:29], v[20:21], 1.0 op_sel_hi:[1,1,0]
  v_pk_fma_f32 v[30:31], v[30:31], v[22:23], 1.0 op_sel_hi:[1,1,0]
  v_rcp_f32 v24, v24
  v_rcp_f32 v25, v25
  v_rcp_f32 v26, v26
  v_rcp_f32 v27, v27
  v_rcp_f32 v28, v28
  v_rcp_f32 v29, v29
  v_rcp_f32 v30, v30
  v_rcp_f32 v31, v31
  v_pk_fma_f32 v[152:153], v[152:153], v[24:25], v[152:153] neg_lo:[1,0,0] neg_hi:[1,0,0]
  v_pk_fma_f32 v[154:155], v[154:155], v[26:27], v[154:155] neg_lo:[1,0,0] neg_hi:[1,0,0]
  v_pk_fma_f32 v[156:157], v[156:157], v[28:29], v[156:157] neg_lo:[1,0,0] neg_hi:[1,0,0]
  v_pk_fma_f32 v[158:159], v[158:159], v[30:31], v[158:159] neg_lo:[1,0,0] neg_hi:[1,0,0]
  v_cvt_pk_bf16_f32 v32, v152, v153
  v_cvt_pk_bf16_f32 v33, v154, v155
  v_cvt_pk_bf16_f32 v34, v156, v157
  v_cvt_pk_bf16_f32 v35, v158, v159
  buffer_store_dwordx4 v[32:35], v250, s[32:35], s71 offen offset:2048 sc1
  v_pk_mul_f32 v[16:17], v[176:177], s[0:1] op_sel_hi:[1,0]
  v_pk_mul_f32 v[18:19], v[178:179], s[0:1] op_sel_hi:[1,0]
  v_pk_mul_f32 v[20:21], v[180:181], s[0:1] op_sel_hi:[1,0]
  v_pk_mul_f32 v[22:23], v[182:183], s[0:1] op_sel_hi:[1,0]
  v_exp_f32 v16, v16
  v_exp_f32 v17, v17
  v_exp_f32 v18, v18
  v_exp_f32 v19, v19
  v_exp_f32 v20, v20
  v_exp_f32 v21, v21
  v_exp_f32 v22, v22
  v_exp_f32 v23, v23
  v_pk_fma_f32 v[24:25], v[16:17], 0.5, 1.0 op_sel_hi:[1,0,0]
  v_pk_fma_f32 v[26:27], v[18:19], 0.5, 1.0 op_sel_hi:[1,0,0]
  v_pk_fma_f32 v[28:29], v[20:21], 0.5, 1.0 op_sel_hi:[1,0,0]
  v_pk_fma_f32 v[30:31], v[22:23], 0.5, 1.0 op_sel_hi:[1,0,0]
  v_pk_fma_f32 v[24:25], v[24:25], v[16:17], 1.0 op_sel_hi:[1,1,0]
  v_pk_fma_f32 v[26:27], v[26:27], v[18:19], 1.0 op_sel_hi:[1,1,0]
  v_pk_fma_f32 v[28:29], v[28:29], v[20:21], 1.0 op_sel_hi:[1,1,0]
  v_pk_fma_f32 v[30:31], v[30:31], v[22:23], 1.0 op_sel_hi:[1,1,0]
  v_rcp_f32 v24, v24
  v_rcp_f32 v25, v25
  v_rcp_f32 v26, v26
  v_rcp_f32 v27, v27
  v_rcp_f32 v28, v28
  v_rcp_f32 v29, v29
  v_rcp_f32 v30, v30
  v_rcp_f32 v31, v31
  v_pk_fma_f32 v[176:177], v[176:177], v[24:25], v[176:177] neg_lo:[1,0,0] neg_hi:[1,0,0]
  v_pk_fma_f32 v[178:179], v[178:179], v[26:27], v[178:179] neg_lo:[1,0,0] neg_hi:[1,0,0]
  v_pk_fma_f32 v[180:181], v[180:181], v[28:29], v[180:181] neg_lo:[1,0,0] neg_hi:[1,0,0]
  v_pk_fma_f32 v[182:183], v[182:183], v[30:31], v[182:183] neg_lo:[1,0,0] neg_hi:[1,0,0]
  v_cvt_pk_bf16_f32 v36, v176, v177
  v_cvt_pk_bf16_f32 v37, v178, v179
  v_cvt_pk_bf16_f32 v38, v180, v181
  v_cvt_pk_bf16_f32 v39, v182, v183
  buffer_store_dwordx4 v[36:39], v250, s[32:35], s71 offen offset:3072 sc1
  s_add_u32 s71, s71, 131072
  s_cmp_ge_u32 s43, 3
  s_cselect_b32 s65, s53, 0
  s_cmp_eq_u32 s65, 1
  s_cbranch_scc1 Lffn_done
  v_pk_mul_f32 v[16:17], v[112:113], s[0:1] op_sel_hi:[1,0]
  v_pk_mul_f32 v[18:19], v[114:115], s[0:1] op_sel_hi:[1,0]
  v_pk_mul_f32 v[20:21], v[116:117], s[0:1] op_sel_hi:[1,0]
  v_pk_mul_f32 v[22:23], v[118:119], s[0:1] op_sel_hi:[1,0]
  v_exp_f32 v16, v16
  v_exp_f32 v17, v17
  v_exp_f32 v18, v18
  v_exp_f32 v19, v19
  v_exp_f32 v20, v20
  v_exp_f32 v21, v21
  v_exp_f32 v22, v22
  v_exp_f32 v23, v23
  v_pk_fma_f32 v[24:25], v[16:17], 0.5, 1.0 op_sel_hi:[1,0,0]
  v_pk_fma_f32 v[26:27], v[18:19], 0.5, 1.0 op_sel_hi:[1,0,0]
  v_pk_fma_f32 v[28:29], v[20:21], 0.5, 1.0 op_sel_hi:[1,0,0]
  v_pk_fma_f32 v[30:31], v[22:23], 0.5, 1.0 op_sel_hi:[1,0,0]
  v_pk_fma_f32 v[24:25], v[24:25], v[16:17], 1.0 op_sel_hi:[1,1,0]
  v_pk_fma_f32 v[26:27], v[26:27], v[18:19], 1.0 op_sel_hi:[1,1,0]
  v_pk_fma_f32 v[28:29], v[28:29], v[20:21], 1.0 op_sel_hi:[1,1,0]
  v_pk_fma_f32 v[30:31], v[30:31], v[22:23], 1.0 op_sel_hi:[1,1,0]
  v_rcp_f32 v24, v24
  v_rcp_f32 v25, v25
  v_rcp_f32 v26, v26
  v_rcp_f32 v27, v27
  v_rcp_f32 v28, v28
  v_rcp_f32 v29, v29
  v_rcp_f32 v30, v30
  v_rcp_f32 v31, v31
  v_pk_fma_f32 v[112:113], v[112:113], v[24:25], v[112:113] neg_lo:[1,0,0] neg_hi:[1,0,0]
  v_pk_fma_f32 v[114:115], v[114:115], v[26:27], v[114:115] neg_lo:[1,0,0] neg_hi:[1,0,0]
  v_pk_fma_f32 v[116:117], v[116:117], v[28:29], v[116:117] neg_lo:[1,0,0] neg_hi:[1,0,0]
  v_pk_fma_f32 v[118:119], v[118:119], v[30:31], v[118:119] neg_lo:[1,0,0] neg_hi:[1,0,0]
  v_cvt_pk_bf16_f32 v32, v112, v113
  v_cvt_pk_bf16_f32 v33, v114, v115
  v_cvt_pk_bf16_f32 v34, v116, v117
  v_cvt_pk_bf16_f32 v35, v118, v119
  buffer_store_dwordx4 v[32:35], v250, s[32:35], s71 offen offset:0 sc1
  v_pk_mul_f32 v[16:17], v[136:137], s[0:1] op_sel_hi:[1,0]
  v_pk_mul_f32 v[18:19], v[138:139], s[0:1] op_sel_hi:[1,0]
  v_pk_mul_f32 v[20:21], v[140:141], s[0:1] op_sel_hi:[1,0]
  v_pk_mul_f32 v[22:23], v[142:143], s[0:1] op_sel_hi:[1,0]
  v_exp_f32 v16, v16
  v_exp_f32 v17, v17
  v_exp_f32 v18, v18
  v_exp_f32 v19, v19
  v_exp_f32 v20, v20
  v_exp_f32 v21, v21
  v_exp_f32 v22, v22
  v_exp_f32 v23, v23
  v_pk_fma_f32 v[24:25], v[16:17], 0.5, 1.0 op_sel_hi:[1,0,0]
  v_pk_fma_f32 v[26:27], v[18:19], 0.5, 1.0 op_sel_hi:[1,0,0]
  v_pk_fma_f32 v[28:29], v[20:21], 0.5, 1.0 op_sel_hi:[1,0,0]
  v_pk_fma_f32 v[30:31], v[22:23], 0.5, 1.0 op_sel_hi:[1,0,0]
  v_pk_fma_f32 v[24:25], v[24:25], v[16:17], 1.0 op_sel_hi:[1,1,0]
  v_pk_fma_f32 v[26:27], v[26:27], v[18:19], 1.0 op_sel_hi:[1,1,0]
  v_pk_fma_f32 v[28:29], v[28:29], v[20:21], 1.0 op_sel_hi:[1,1,0]
  v_pk_fma_f32 v[30:31], v[30:31], v[22:23], 1.0 op_sel_hi:[1,1,0]
  v_rcp_f32 v24, v24
  v_rcp_f32 v25, v25
  v_rcp_f32 v26, v26
  v_rcp_f32 v27, v27
  v_rcp_f32 v28, v28
  v_rcp_f32 v29, v29
  v_rcp_f32 v30, v30
  v_rcp_f32 v31, v31
  v_pk_fma_f32 v[136:137], v[136:137], v[24:25], v[136:137] neg_lo:[1,0,0] neg_hi:[1,0,0]
  v_pk_fma_f32 v[138:139], v[138:139], v[26:27], v[138:139] neg_lo:[1,0,0] neg_hi:[1,0,0]
  v_pk_fma_f32 v[140:141], v[140:141], v[28:29], v[140:141] neg_lo:[1,0,0] neg_hi:[1,0,0]
  v_pk_fma_f32 v[142:143], v[142:143], v[30:31], v[142:143] neg_lo:[1,0,0] neg_hi:[1,0,0]
  v_cvt_pk_bf16_f32 v36, v136, v137
  v_cvt_pk_bf16_f32 v37, v138, v139
  v_cvt_pk_bf16_f32 v38, v140, v141
  v_cvt_pk_bf16_f32 v39, v142, v143
  buffer_store_dwordx4 v[36:39], v250, s[32:35], s71 offen offset:1024 sc1
  v_pk_mul_f32 v[16:17], v[160:161], s[0:1] op_sel_hi:[1,0]
  v_pk_mul_f32 v[18:19], v[162:163], s[0:1] op_sel_hi:[1,0]
  v_pk_mul_f32 v[20:21], v[164:165], s[0:1] op_sel_hi:[1,0]
  v_pk_mul_f32 v[22:23], v[166:167], s[0:1] op_sel_hi:[1,0]
  v_exp_f32 v16, v16
  v_exp_f32 v17, v17
  v_exp_f32 v18, v18
  v_exp_f32 v19, v19
  v_exp_f32 v20, v20
  v_exp_f32 v21, v21
  v_exp_f32 v22, v22
  v_exp_f32 v23, v23
  v_pk_fma_f32 v[24:25], v[16:17], 0.5, 1.0 op_sel_hi:[1,0,0]
  v_pk_fma_f32 v[26:27], v[18:19], 0.5, 1.0 op_sel_hi:[1,0,0]
  v_pk_fma_f32 v[28:29], v[20:21], 0.5, 1.0 op_sel_hi:[1,0,0]
  v_pk_fma_f32 v[30:31], v[22:23], 0.5, 1.0 op_sel_hi:[1,0,0]
  v_pk_fma_f32 v[24:25], v[24:25], v[16:17], 1.0 op_sel_hi:[1,1,0]
  v_pk_fma_f32 v[26:27], v[26:27], v[18:19], 1.0 op_sel_hi:[1,1,0]
  v_pk_fma_f32 v[28:29], v[28:29], v[20:21], 1.0 op_sel_hi:[1,1,0]
  v_pk_fma_f32 v[30:31], v[30:31], v[22:23], 1.0 op_sel_hi:[1,1,0]
  v_rcp_f32 v24, v24
  v_rcp_f32 v25, v25
  v_rcp_f32 v26, v26
  v_rcp_f32 v27, v27
  v_rcp_f32 v28, v28
  v_rcp_f32 v29, v29
  v_rcp_f32 v30, v30
  v_rcp_f32 v31, v31
  v_pk_fma_f32 v[160:161], v[160:161], v[24:25], v[160:161] neg_lo:[1,0,0] neg_hi:[1,0,0]
  v_pk_fma_f32 v[162:163], v[162:163], v[26:27], v[162:163] neg_lo:[1,0,0] neg_hi:[1,0,0]
  v_pk_fma_f32 v[164:165], v[164:165], v[28:29], v[164:165] neg_lo:[1,0,0] neg_hi:[1,0,0]
  v_pk_fma_f32 v[166:167], v[166:167], v[30:31], v[166:167] neg_lo:[1,0,0] neg_hi:[1,0,0]
  v_cvt_pk_bf16_f32 v32, v160, v161
  v_cvt_pk_bf16_f32 v33, v162, v163
  v_cvt_pk_bf16_f32 v34, v164, v165
  v_cvt_pk_bf16_f32 v35, v166, v167
  buffer_store_dwordx4 v[32:35], v250, s[32:35], s71 offen offset:2048 sc1
  v_pk_mul_f32 v[16:17], v[184:185], s[0:1] op_sel_hi:[1,0]
  v_pk_mul_f32 v[18:19], v[186:187], s[0:1] op_sel_hi:[1,0]
  v_pk_mul_f32 v[20:21], v[188:189], s[0:1] op_sel_hi:[1,0]
  v_pk_mul_f32 v[22:23], v[190:191], s[0:1] op_sel_hi:[1,0]
  v_exp_f32 v16, v16
  v_exp_f32 v17, v17
  v_exp_f32 v18, v18
  v_exp_f32 v19, v19
  v_exp_f32 v20, v20
  v_exp_f32 v21, v21
  v_exp_f32 v22, v22
  v_exp_f32 v23, v23
  v_pk_fma_f32 v[24:25], v[16:17], 0.5, 1.0 op_sel_hi:[1,0,0]
  v_pk_fma_f32 v[26:27], v[18:19], 0.5, 1.0 op_sel_hi:[1,0,0]
  v_pk_fma_f32 v[28:29], v[20:21], 0.5, 1.0 op_sel_hi:[1,0,0]
  v_pk_fma_f32 v[30:31], v[22:23], 0.5, 1.0 op_sel_hi:[1,0,0]
  v_pk_fma_f32 v[24:25], v[24:25], v[16:17], 1.0 op_sel_hi:[1,1,0]
  v_pk_fma_f32 v[26:27], v[26:27], v[18:19], 1.0 op_sel_hi:[1,1,0]
  v_pk_fma_f32 v[28:29], v[28:29], v[20:21], 1.0 op_sel_hi:[1,1,0]
  v_pk_fma_f32 v[30:31], v[30:31], v[22:23], 1.0 op_sel_hi:[1,1,0]
  v_rcp_f32 v24, v24
  v_rcp_f32 v25, v25
  v_rcp_f32 v26, v26
  v_rcp_f32 v27, v27
  v_rcp_f32 v28, v28
  v_rcp_f32 v29, v29
  v_rcp_f32 v30, v30
  v_rcp_f32 v31, v31
  v_pk_fma_f32 v[184:185], v[184:185], v[24:25], v[184:185] neg_lo:[1,0,0] neg_hi:[1,0,0]
  v_pk_fma_f32 v[186:187], v[186:187], v[26:27], v[186:187] neg_lo:[1,0,0] neg_hi:[1,0,0]
  v_pk_fma_f32 v[188:189], v[188:189], v[28:29], v[188:189] neg_lo:[1,0,0] neg_hi:[1,0,0]
  v_pk_fma_f32 v[190:191], v[190:191], v[30:31], v[190:191] neg_lo:[1,0,0] neg_hi:[1,0,0]
  v_cvt_pk_bf16_f32 v36, v184, v185
  v_cvt_pk_bf16_f32 v37, v186, v187
  v_cvt_pk_bf16_f32 v38, v188, v189
  v_cvt_pk_bf16_f32 v39, v190, v191
  buffer_store_dwordx4 v[36:39], v250, s[32:35], s71 offen offset:3072 sc1
  s_add_u32 s71, s71, 131072
Lffn_done:
  v_cmp_eq_u32 s[68:69], 0, v1
  s_nop 1
  s_and_saveexec_b64 s[66:67], s[68:69]
  buffer_store_dwordx2 v[56:57], v86, s[36:39], 0 offen sc1
  s_mov_b64 exec, s[66:67]
  v_mov_b32 v0, v93
  v_lshlrev_b32 v4, 4, v1
  s_lshl_b32 s66, s12, 12
  s_add_u32 s65, s40, 0
  s_and_b32 s65, s65, 3
  s_lshl_b32 s65, s65, 10
  s_add_u32 s65, s65, s66
  v_add_u32 v8, s65, v4
  s_add_u32 s65, s40, 1
  s_and_b32 s65, s65, 3
  s_lshl_b32 s65, s65, 10
  s_add_u32 s65, s65, s66
  v_add_u32 v9, s65, v4
  s_add_u32 s65, s40, 2
  s_and_b32 s65, s65, 3
  s_lshl_b32 s65, s65, 10
  s_add_u32 s65, s65, s66
  v_add_u32 v10, s65, v4
  s_add_u32 s65, s40, 3
  s_and_b32 s65, s65, 3
  s_lshl_b32 s65, s65, 10
  s_add_u32 s65, s65, s66
  v_add_u32 v11, s65, v4
  s_mov_b32 s16, s48
  s_and_b32 s17, s49, 0xffff
  s_mov_b32 s18, 2097152
  s_mov_b32 s19, 0x00020000
  s_waitcnt vmcnt(9)
  v_add_u32 v60, s96, v88
  v_add_u32 v61, s96, v89
  v_add_u32 v62, s96, v90
  v_add_u32 v63, s96, v91
  ds_read_b64_tr_b16 a[0:1], v60 offset:0
  ds_read_b64_tr_b16 a[2:3], v60 offset:2048
  ds_read_b64_tr_b16 a[4:5], v61 offset:0
  ds_read_b64_tr_b16 a[6:7], v61 offset:2048
  ds_read_b64_tr_b16 a[8:9], v62 offset:0
  ds_read_b64_tr_b16 a[10:11], v62 offset:2048
  ds_read_b64_tr_b16 a[12:13], v63 offset:0
  ds_read_b64_tr_b16 a[14:15], v63 offset:2048
  ds_read_b64_tr_b16 a[16:17], v60 offset:4096
  ds_read_b64_tr_b16 a[18:19], v60 offset:6144
  ds_read_b64_tr_b16 a[20:21], v61 offset:4096
  ds_read_b64_tr_b16 a[22:23], v61 offset:6144
  ds_read_b64_tr_b16 a[24:25], v62 offset:4096
  ds_read_b64_tr_b16 a[26:27], v62 offset:6144
  ds_read_b64_tr_b16 a[28:29], v63 offset:4096
  ds_read_b64_tr_b16 a[30:31], v63 offset:6144
  ds_read_b64_tr_b16 a[32:33], v60 offset:8192
  ds_read_b64_tr_b16 a[34:35], v60 offset:10240
  ds_read_b64_tr_b16 a[36:37], v61 offset:8192
  ds_read_b64_tr_b16 a[38:39], v61 offset:10240
  ds_read_b64_tr_b16 a[40:41], v62 offset:8192
  ds_read_b64_tr_b16 a[42:43], v62 offset:10240
  ds_read_b64_tr_b16 a[44:45], v63 offset:8192
  ds_read_b64_tr_b16 a[46:47], v63 offset:10240
  ds_read_b64_tr_b16 a[48:49], v60 offset:12288
  ds_read_b64_tr_b16 a[50:51], v60 offset:14336
  ds_read_b64_tr_b16 a[52:53], v61 offset:12288
  ds_read_b64_tr_b16 a[54:55], v61 offset:14336
  ds_read_b64_tr_b16 a[56:57], v62 offset:12288
  ds_read_b64_tr_b16 a[58:59], v62 offset:14336
  ds_read_b64_tr_b16 a[60:61], v63 offset:12288
  ds_read_b64_tr_b16 a[62:63], v63 offset:14336
  v_add_u32 v60, s97, v88
  v_add_u32 v61, s97, v89
  v_add_u32 v62, s97, v90
  v_add_u32 v63, s97, v91
  ds_read_b64_tr_b16 a[64:65], v60 offset:0
  ds_read_b64_tr_b16 a[66:67], v60 offset:2048
  ds_read_b64_tr_b16 a[68:69], v61 offset:0
  ds_read_b64_tr_b16 a[70:71], v61 offset:2048
  ds_read_b64_tr_b16 a[72:73], v62 offset:0
  ds_read_b64_tr_b16 a[74:75], v62 offset:2048
  ds_read_b64_tr_b16 a[76:77], v63 offset:0
  ds_read_b64_tr_b16 a[78:79], v63 offset:2048
  ds_read_b64_tr_b16 a[80:81], v60 offset:4096
  ds_read_b64_tr_b16 a[82:83], v60 offset:6144
  ds_read_b64_tr_b16 a[84:85], v61 offset:4096
  ds_read_b64_tr_b16 a[86:87], v61 offset:6144
  ds_read_b64_tr_b16 a[88:89], v62 offset:4096
  ds_read_b64_tr_b16 a[90:91], v62 offset:6144
  ds_read_b64_tr_b16 a[92:93], v63 offset:4096
  ds_read_b64_tr_b16 a[94:95], v63 offset:6144
  v_add_u32 v60, s98, v88
  v_add_u32 v61, s98, v89
  v_add_u32 v62, s98, v90
  v_add_u32 v63, s98, v91
  ds_read_b64_tr_b16 a[96:97], v60 offset:0
  ds_read_b64_tr_b16 a[98:99], v60 offset:2048
  ds_read_b64_tr_b16 a[100:101], v61 offset:0
  ds_read_b64_tr_b16 a[102:103], v61 offset:2048
  ds_read_b64_tr_b16 a[104:105], v62 offset:0
  ds_read_b64_tr_b16 a[106:107], v62 offset:2048
  ds_read_b64_tr_b16 a[108:109], v63 offset:0
  ds_read_b64_tr_b16 a[110:111], v63 offset:2048
  v_add_u32 v60, s99, v88
  v_add_u32 v61, s99, v89
  v_add_u32 v62, s99, v90
  v_add_u32 v63, s99, v91
  ds_read_b64_tr_b16 a[112:113], v60 offset:0
  ds_read_b64_tr_b16 a[114:115], v60 offset:2048
  ds_read_b64_tr_b16 a[116:117], v61 offset:0
  ds_read_b64_tr_b16 a[118:119], v61 offset:2048
  ds_read_b64_tr_b16 a[120:121], v62 offset:0
  ds_read_b64_tr_b16 a[122:123], v62 offset:2048
  ds_read_b64_tr_b16 a[124:125], v63 offset:0
  ds_read_b64_tr_b16 a[126:127], v63 offset:2048
  v_add_u32 v60, s100, v88
  v_add_u32 v61, s100, v89
  v_add_u32 v62, s100, v90
  v_add_u32 v63, s100, v91
  ds_read_b64_tr_b16 a[128:129], v60 offset:0
  ds_read_b64_tr_b16 a[130:131], v60 offset:2048
  ds_read_b64_tr_b16 a[132:133], v61 offset:0
  ds_read_b64_tr_b16 a[134:135], v61 offset:2048
  ds_read_b64_tr_b16 a[136:137], v62 offset:0
  ds_read_b64_tr_b16 a[138:139], v62 offset:2048
  ds_read_b64_tr_b16 a[140:141], v63 offset:0
  ds_read_b64_tr_b16 a[142:143], v63 offset:2048
  s_waitcnt lgkmcnt(0)
  s_lshl_b32 s45, s44, 15
  s_add_u32 s44, s44, 1
  s_cmp_eq_u32 s44, s15
  s_cselect_b32 s44, 0, s44
  s_add_u32 m0, s96, 0
  s_add_u32 s57, s45, 0
  s_nop 0
  buffer_load_dwordx4 v87, s[24:27], s57 offen lds
  s_add_u32 m0, s96, 1024
  s_add_u32 s57, s45, 8192
  s_nop 0
  buffer_load_dwordx4 v87, s[24:27], s57 offen lds
  s_add_u32 m0, s96, 2048
  s_add_u32 s57, s45, 16384
  s_nop 0
  buffer_load_dwordx4 v87, s[24:27], s57 offen lds
  s_add_u32 m0, s96, 3072
  s_add_u32 s57, s45, 24576
  s_nop 0
  buffer_load_dwordx4 v87, s[24:27], s57 offen lds
  s_waitcnt vmcnt(4)
  s_barrier
  v_mov_b32 v5, 1
  buffer_store_dword v5, v94, s[36:39], 0 offen sc1
Lphase2:
  s_lshl_b32 s45, s44, 15
  s_add_u32 s44, s44, 1
  s_cmp_eq_u32 s44, s15
  s_cselect_b32 s44, 0, s44
  s_add_u32 m0, s96, 4096
  s_add_u32 s57, s45, 0
  s_nop 0
  buffer_load_dwordx4 v87, s[24:27], s57 offen lds
  s_add_u32 m0, s96, 5120
  s_add_u32 s57, s45, 8192
  s_nop 0
  buffer_load_dwordx4 v87, s[24:27], s57 offen lds
  s_add_u32 m0, s96, 6144
  s_add_u32 s57, s45, 16384
  s_nop 0
  buffer_load_dwordx4 v87, s[24:27], s57 offen lds
  s_add_u32 m0, s96, 7168
  s_add_u32 s57, s45, 24576
  s_nop 0
  buffer_load_dwordx4 v87, s[24:27], s57 offen lds
  s_lshl_b32 s45, s44, 15
  s_add_u32 s44, s44, 1
  s_cmp_eq_u32 s44, s15
  s_cselect_b32 s44, 0, s44
  s_add_u32 m0, s96, 8192
  s_add_u32 s57, s45, 0
  s_nop 0
  buffer_load_dwordx4 v87, s[24:27], s57 offen lds
  s_add_u32 m0, s96, 9216
  s_add_u32 s57, s45, 8192
  s_nop 0
  buffer_load_dwordx4 v87, s[24:27], s57 offen lds
  s_add_u32 m0, s96, 10240
  s_add_u32 s57, s45, 16384
  s_nop 0
  buffer_load_dwordx4 v87, s[24:27], s57 offen lds
  s_add_u32 m0, s96, 11264
  s_add_u32 s57, s45, 24576
  s_nop 0
  buffer_load_dwordx4 v87, s[24:27], s57 offen lds
  s_lshl_b32 s45, s44, 15
  s_add_u32 s44, s44, 1
  s_cmp_eq_u32 s44, s15
  s_cselect_b32 s44, 0, s44
  s_add_u32 m0, s96, 12288
  s_add_u32 s57, s45, 0
  s_nop 0
  buffer_load_dwordx4 v87, s[24:27], s57 offen lds
  s_add_u32 m0, s96, 13312
  s_add_u32 s57, s45, 8192
  s_nop 0
  buffer_load_dwordx4 v87, s[24:27], s57 offen lds
  s_add_u32 m0, s96, 14336
  s_add_u32 s57, s45, 16384
  s_nop 0
  buffer_load_dwordx4 v87, s[24:27], s57 offen lds
  s_add_u32 m0, s96, 15360
  s_add_u32 s57, s45, 24576
  s_nop 0
  buffer_load_dwordx4 v87, s[24:27], s57 offen lds
  s_lshl_b32 s45, s44, 15
  s_add_u32 s44, s44, 1
  s_cmp_eq_u32 s44, s15
  s_cselect_b32 s44, 0, s44
  s_add_u32 m0, s97, 0
  s_add_u32 s57, s45, 0
  s_nop 0
  buffer_load_dwordx4 v87, s[24:27], s57 offen lds
  s_add_u32 m0, s97, 1024
  s_add_u32 s57, s45, 8192
  s_nop 0
  buffer_load_dwordx4 v87, s[24:27], s57 offen lds
  s_add_u32 m0, s97, 2048
  s_add_u32 s57, s45, 16384
  s_nop 0
  buffer_load_dwordx4 v87, s[24:27], s57 offen lds
  s_add_u32 m0, s97, 3072
  s_add_u32 s57, s45, 24576
  s_nop 0
  buffer_load_dwordx4 v87, s[24:27], s57 offen lds
  s_cmp_gt_u32 s15, 14
  s_cbranch_scc0 Lp2_nomore
  s_cmp_gt_u32 s15, 14
  s_cselect_b32 s45, s44, 31
  s_lshl_b32 s45, s45, 15
  s_add_u32 s44, s44, 1
  s_cmp_eq_u32 s44, s15
  s_cselect_b32 s44, 0, s44
  s_add_u32 m0, s97, 4096
  s_add_u32 s57, s45, 0
  s_nop 0
  buffer_load_dwordx4 v87, s[24:27], s57 offen lds
  s_add_u32 m0, s97, 5120
  s_add_u32 s57, s45, 8192
  s_nop 0
  buffer_load_dwordx4 v87, s[24:27], s57 offen lds
  s_add_u32 m0, s97, 6144
  s_add_u32 s57, s45, 16384
  s_nop 0
  buffer_load_dwordx4 v87, s[24:27], s57 offen lds
  s_add_u32 m0, s97, 7168
  s_add_u32 s57, s45, 24576
  s_nop 0
  buffer_load_dwordx4 v87, s[24:27], s57 offen lds
  s_cmp_gt_u32 s15, 15
  s_cbranch_scc0 Lp2_nomore
  s_cmp_gt_u32 s15, 15
  s_cselect_b32 s45, s44, 31
  s_lshl_b32 s45, s45, 15
  s_add_u32 s44, s44, 1
  s_cmp_eq_u32 s44, s15
  s_cselect_b32 s44, 0, s44
  s_add_u32 m0, s98, 0
  s_add_u32 s57, s45, 0
  s_nop 0
  buffer_load_dwordx4 v87, s[24:27], s57 offen lds
  s_add_u32 m0, s98, 1024
  s_add_u32 s57, s45, 8192
  s_nop 0
  buffer_load_dwordx4 v87, s[24:27], s57 offen lds
  s_add_u32 m0, s98, 2048
  s_add_u32 s57, s45, 16384
  s_nop 0
  buffer_load_dwordx4 v87, s[24:27], s57 offen lds
  s_add_u32 m0, s98, 3072
  s_add_u32 s57, s45, 24576
  s_nop 0
  buffer_load_dwordx4 v87, s[24:27], s57 offen lds
Lp2_nomore:
  s_lshr_b32 s67, s12, 1
  s_lshl_b32 s67, s67, 7
  s_add_u32 s67, s67, 16384
  v_and_b32 v5, 15, v1
  v_lshl_add_u32 v5, v5, 3, s67
  v_readfirstlane_b32 s68, v64
  s_cmp_eq_u32 s40, 0
  s_cbranch_scc0 Lp2_other
  s_mov_b32 s66, 0
Lp2_clr:
  s_cmp_ge_u32 s68, 16
  s_cbranch_scc1 Lp2_cleared
  s_sleep 8
  global_load_dword v64, v43, s[50:51] sc1
  s_add_u32 s66, s66, 1
  s_waitcnt vmcnt(0)
  v_readfirstlane_b32 s68, v64
  s_cmp_gt_u32 s66, 0x100000
  s_cbranch_scc0 Lp2_clr
Lp2_cleared:
  buffer_load_dword v6, v5, s[36:39], 0 offen sc1
  s_waitcnt vmcnt(1)
  v_add_u32 v60, s96, v88
  v_add_u32 v61, s96, v89
  v_add_u32 v62, s96, v90
  v_add_u32 v63, s96, v91
  ds_read_b64_tr_b16 a[144:145], v60 offset:0
  ds_read_b64_tr_b16 a[146:147], v60 offset:2048
  ds_read_b64_tr_b16 a[148:149], v61 offset:0
  ds_read_b64_tr_b16 a[150:151], v61 offset:2048
  ds_read_b64_tr_b16 a[152:153], v62 offset:0
  ds_read_b64_tr_b16 a[154:155], v62 offset:2048
  ds_read_b64_tr_b16 a[156:157], v63 offset:0
  ds_read_b64_tr_b16 a[158:159], v63 offset:2048
  ds_read_b64_tr_b16 a[160:161], v60 offset:4096
  ds_read_b64_tr_b16 a[162:163], v60 offset:6144
  ds_read_b64_tr_b16 a[164:165], v61 offset:4096
  ds_read_b64_tr_b16 a[166:167], v61 offset:6144
  ds_read_b64_tr_b16 a[168:169], v62 offset:4096
  ds_read_b64_tr_b16 a[170:171], v62 offset:6144
  ds_read_b64_tr_b16 a[172:173], v63 offset:4096
  ds_read_b64_tr_b16 a[174:175], v63 offset:6144
  ds_read_b64_tr_b16 a[176:177], v60 offset:8192
  ds_read_b64_tr_b16 a[178:179], v60 offset:10240
  ds_read_b64_tr_b16 a[180:181], v61 offset:8192
  ds_read_b64_tr_b16 a[182:183], v61 offset:10240
  ds_read_b64_tr_b16 a[184:185], v62 offset:8192
  ds_read_b64_tr_b16 a[186:187], v62 offset:10240
  ds_read_b64_tr_b16 a[188:189], v63 offset:8192
  ds_read_b64_tr_b16 a[190:191], v63 offset:10240
  ds_read_b64_tr_b16 a[192:193], v60 offset:12288
  ds_read_b64_tr_b16 a[194:195], v60 offset:14336
  ds_read_b64_tr_b16 a[196:197], v61 offset:12288
  ds_read_b64_tr_b16 a[198:199], v61 offset:14336
  ds_read_b64_tr_b16 a[200:201], v62 offset:12288
  ds_read_b64_tr_b16 a[202:203], v62 offset:14336
  ds_read_b64_tr_b16 a[204:205], v63 offset:12288
  ds_read_b64_tr_b16 a[206:207], v63 offset:14336
  v_add_u32 v60, s97, v88
  v_add_u32 v61, s97, v89
  v_add_u32 v62, s97, v90
  v_add_u32 v63, s97, v91
  ds_read_b64_tr_b16 a[208:209], v60 offset:0
  ds_read_b64_tr_b16 a[210:211], v60 offset:2048
  ds_read_b64_tr_b16 a[212:213], v61 offset:0
  ds_read_b64_tr_b16 a[214:215], v61 offset:2048
  ds_read_b64_tr_b16 a[216:217], v62 offset:0
  ds_read_b64_tr_b16 a[218:219], v62 offset:2048
  ds_read_b64_tr_b16 a[220:221], v63 offset:0
  ds_read_b64_tr_b16 a[222:223], v63 offset:2048
  ds_read_b64_tr_b16 a[224:225], v60 offset:4096
  ds_read_b64_tr_b16 a[226:227], v60 offset:6144
  ds_read_b64_tr_b16 a[228:229], v61 offset:4096
  ds_read_b64_tr_b16 a[230:231], v61 offset:6144
  ds_read_b64_tr_b16 a[232:233], v62 offset:4096
  ds_read_b64_tr_b16 a[234:235], v62 offset:6144
  ds_read_b64_tr_b16 a[236:237], v63 offset:4096
  ds_read_b64_tr_b16 a[238:239], v63 offset:6144
  v_add_u32 v60, s98, v88
  v_add_u32 v61, s98, v89
  v_add_u32 v62, s98, v90
  v_add_u32 v63, s98, v91
  ds_read_b64_tr_b16 a[240:241], v60 offset:0
  ds_read_b64_tr_b16 a[242:243], v60 offset:2048
  ds_read_b64_tr_b16 a[244:245], v61 offset:0
  ds_read_b64_tr_b16 a[246:247], v61 offset:2048
  ds_read_b64_tr_b16 a[248:249], v62 offset:0
  ds_read_b64_tr_b16 a[250:251], v62 offset:2048
  ds_read_b64_tr_b16 a[252:253], v63 offset:0
  ds_read_b64_tr_b16 a[254:255], v63 offset:2048
  s_waitcnt vmcnt(0)
  s_branch Lp2_check
Lp2_poll:
  s_sleep 1
  buffer_load_dword v6, v5, s[36:39], 0 offen sc1
  s_add_u32 s66, s66, 1
  s_waitcnt vmcnt(0)
  s_cmp_gt_u32 s66, 0x200000
  s_cbranch_scc1 Lp2_go
Lp2_check:
  v_cmp_ne_u32 vcc, 1, v6
  s_nop 4
  s_cbranch_vccnz Lp2_poll
  s_branch Lp2_go
Lp2_other:
  s_waitcnt vmcnt(0)
  v_add_u32 v60, s96, v88
  v_add_u32 v61, s96, v89
  v_add_u32 v62, s96, v90
  v_add_u32 v63, s96, v91
  ds_read_b64_tr_b16 a[144:145], v60 offset:0
  ds_read_b64_tr_b16 a[146:147], v60 offset:2048
  ds_read_b64_tr_b16 a[148:149], v61 offset:0
  ds_read_b64_tr_b16 a[150:151], v61 offset:2048
  ds_read_b64_tr_b16 a[152:153], v62 offset:0
  ds_read_b64_tr_b16 a[154:155], v62 offset:2048
  ds_read_b64_tr_b16 a[156:157], v63 offset:0
  ds_read_b64_tr_b16 a[158:159], v63 offset:2048
  ds_read_b64_tr_b16 a[160:161], v60 offset:4096
  ds_read_b64_tr_b16 a[162:163], v60 offset:6144
  ds_read_b64_tr_b16 a[164:165], v61 offset:4096
  ds_read_b64_tr_b16 a[166:167], v61 offset:6144
  ds_read_b64_tr_b16 a[168:169], v62 offset:4096
  ds_read_b64_tr_b16 a[170:171], v62 offset:6144
  ds_read_b64_tr_b16 a[172:173], v63 offset:4096
  ds_read_b64_tr_b16 a[174:175], v63 offset:6144
  ds_read_b64_tr_b16 a[176:177], v60 offset:8192
  ds_read_b64_tr_b16 a[178:179], v60 offset:10240
  ds_read_b64_tr_b16 a[180:181], v61 offset:8192
  ds_read_b64_tr_b16 a[182:183], v61 offset:10240
  ds_read_b64_tr_b16 a[184:185], v62 offset:8192
  ds_read_b64_tr_b16 a[186:187], v62 offset:10240
  ds_read_b64_tr_b16 a[188:189], v63 offset:8192
  ds_read_b64_tr_b16 a[190:191], v63 offset:10240
  ds_read_b64_tr_b16 a[192:193], v60 offset:12288
  ds_read_b64_tr_b16 a[194:195], v60 offset:14336
  ds_read_b64_tr_b16 a[196:197], v61 offset:12288
  ds_read_b64_tr_b16 a[198:199], v61 offset:14336
  ds_read_b64_tr_b16 a[200:201], v62 offset:12288
  ds_read_b64_tr_b16 a[202:203], v62 offset:14336
  ds_read_b64_tr_b16 a[204:205], v63 offset:12288
  ds_read_b64_tr_b16 a[206:207], v63 offset:14336
  v_add_u32 v60, s97, v88
  v_add_u32 v61, s97, v89
  v_add_u32 v62, s97, v90
  v_add_u32 v63, s97, v91
  ds_read_b64_tr_b16 a[208:209], v60 offset:0
  ds_read_b64_tr_b16 a[210:211], v60 offset:2048
  ds_read_b64_tr_b16 a[212:213], v61 offset:0
  ds_read_b64_tr_b16 a[214:215], v61 offset:2048
  ds_read_b64_tr_b16 a[216:217], v62 offset:0
  ds_read_b64_tr_b16 a[218:219], v62 offset:2048
  ds_read_b64_tr_b16 a[220:221], v63 offset:0
  ds_read_b64_tr_b16 a[222:223], v63 offset:2048
  ds_read_b64_tr_b16 a[224:225], v60 offset:4096
  ds_read_b64_tr_b16 a[226:227], v60 offset:6144
  ds_read_b64_tr_b16 a[228:229], v61 offset:4096
  ds_read_b64_tr_b16 a[230:231], v61 offset:6144
  ds_read_b64_tr_b16 a[232:233], v62 offset:4096
  ds_read_b64_tr_b16 a[234:235], v62 offset:6144
  ds_read_b64_tr_b16 a[236:237], v63 offset:4096
  ds_read_b64_tr_b16 a[238:239], v63 offset:6144
  v_add_u32 v60, s98, v88
  v_add_u32 v61, s98, v89
  v_add_u32 v62, s98, v90
  v_add_u32 v63, s98, v91
  ds_read_b64_tr_b16 a[240:241], v60 offset:0
  ds_read_b64_tr_b16 a[242:243], v60 offset:2048
  ds_read_b64_tr_b16 a[244:245], v61 offset:0
  ds_read_b64_tr_b16 a[246:247], v61 offset:2048
  ds_read_b64_tr_b16 a[248:249], v62 offset:0
  ds_read_b64_tr_b16 a[250:251], v62 offset:2048
  ds_read_b64_tr_b16 a[252:253], v63 offset:0
  ds_read_b64_tr_b16 a[254:255], v63 offset:2048
Lp2_go:
  s_waitcnt lgkmcnt(0)
  s_barrier
  buffer_load_dword v12, v92, s[36:39], 0 offen sc1
  s_mul_i32 s65, s8, 131072
  s_add_u32 s8, s8, 1
  s_cmp_eq_u32 s8, s15
  s_cselect_b32 s8, 0, s8
  buffer_load_dwordx4 v[84:87], v9, s[28:31], s65 offen sc1
  buffer_load_dwordx4 v[88:91], v10, s[28:31], s65 offen sc1
  buffer_load_dwordx4 v[92:95], v11, s[28:31], s65 offen sc1
  buffer_load_dwordx4 v[80:83], v8, s[28:31], s65 offen sc1
  s_mul_i32 s66, s8, 131072
  s_add_u32 s8, s8, 1
  s_cmp_eq_u32 s8, s15
  s_cselect_b32 s8, 0, s8
  buffer_load_dwordx4 v[100:103], v9, s[28:31], s66 offen sc1
  buffer_load_dwordx4 v[104:107], v10, s[28:31], s66 offen sc1
  buffer_load_dwordx4 v[108:111], v11, s[28:31], s66 offen sc1
  buffer_load_dwordx4 v[96:99], v8, s[28:31], s66 offen sc1
  s_mul_i32 s65, s8, 131072
  s_add_u32 s8, s8, 1
  s_cmp_eq_u32 s8, s15
  s_cselect_b32 s8, 0, s8
  buffer_load_dwordx4 v[116:119], v9, s[28:31], s65 offen sc1
  buffer_load_dwordx4 v[120:123], v10, s[28:31], s65 offen sc1
  buffer_load_dwordx4 v[124:127], v11, s[28:31], s65 offen sc1
  buffer_load_dwordx4 v[112:115], v8, s[28:31], s65 offen sc1
  s_mul_i32 s66, s8, 131072
  s_add_u32 s8, s8, 1
  s_cmp_eq_u32 s8, s15
  s_cselect_b32 s8, 0, s8
  buffer_load_dwordx4 v[132:135], v9, s[28:31], s66 offen sc1
  buffer_load_dwordx4 v[136:139], v10, s[28:31], s66 offen sc1
  buffer_load_dwordx4 v[140:143], v11, s[28:31], s66 offen sc1
  buffer_load_dwordx4 v[128:131], v8, s[28:31], s66 offen sc1
  s_waitcnt vmcnt(12)
  v_mfma_f32_16x16x32_bf16 v[32:35], a[0:3], v[84:87], 0
  s_mul_i32 s65, s8, 131072
  s_add_u32 s8, s8, 1
  s_cmp_eq_u32 s8, s15
  s_cselect_b32 s8, 0, s8
  v_mfma_f32_16x16x32_bf16 v[36:39], a[4:7], v[84:87], 0
  buffer_load_dwordx4 v[148:151], v9, s[28:31], s65 offen sc1
  v_mfma_f32_16x16x32_bf16 v[40:43], a[8:11], v[84:87], 0
  v_mfma_f32_16x16x32_bf16 v[44:47], a[12:15], v[84:87], 0
  v_mfma_f32_16x16x32_bf16 v[48:51], a[0:3], v[88:91], 0
  v_mfma_f32_16x16x32_bf16 v[52:55], a[4:7], v[88:91], 0
  buffer_load_dwordx4 v[152:155], v10, s[28:31], s65 offen sc1
  v_mfma_f32_16x16x32_bf16 v[56:59], a[8:11], v[88:91], 0
  v_mfma_f32_16x16x32_bf16 v[60:63], a[12:15], v[88:91], 0
  v_mfma_f32_16x16x32_bf16 v[64:67], a[0:3], v[92:95], 0
  v_mfma_f32_16x16x32_bf16 v[68:71], a[4:7], v[92:95], 0
  buffer_load_dwordx4 v[156:159], v11, s[28:31], s65 offen sc1
  v_mfma_f32_16x16x32_bf16 v[72:75], a[8:11], v[92:95], 0
  v_mfma_f32_16x16x32_bf16 v[76:79], a[12:15], v[92:95], 0
  v_mfma_f32_16x16x32_bf16 v[16:19], a[0:3], v[80:83], 0
  v_mfma_f32_16x16x32_bf16 v[20:23], a[4:7], v[80:83], 0
  buffer_load_dwordx4 v[144:147], v8, s[28:31], s65 offen sc1
  v_mfma_f32_16x16x32_bf16 v[24:27], a[8:11], v[80:83], 0
  v_mfma_f32_16x16x32_bf16 v[28:31], a[12:15], v[80:83], 0
  s_waitcnt vmcnt(12)
  v_mfma_f32_16x16x32_bf16 v[32:35], a[16:19], v[100:103], v[32:35]
  s_mul_i32 s66, s8, 131072
  s_add_u32 s8, s8, 1
  s_cmp_eq_u32 s8, s15
  s_cselect_b32 s8, 0, s8
  v_mfma_f32_16x16x32_bf16 v[36:39], a[20:23], v[100:103], v[36:39]
  buffer_load_dwordx4 v[164:167], v9, s[28:31], s66 offen sc1
  v_mfma_f32_16x16x32_bf16 v[40:43], a[24:27], v[100:103], v[40:43]
  v_mfma_f32_16x16x32_bf16 v[44:47], a[28:31], v[100:103], v[44:47]
  v_lshlrev_b32 v4, 4, v1
  v_add_u32 v4, 114688, v4
  v_mfma_f32_16x16x32_bf16 v[48:51], a[16:19], v[104:107], v[48:51]
  v_mfma_f32_16x16x32_bf16 v[52:55], a[20:23], v[104:107], v[52:55]
  buffer_load_dwordx4 v[168:171], v10, s[28:31], s66 offen sc1
  v_mfma_f32_16x16x32_bf16 v[56:59], a[24:27], v[104:107], v[56:59]
  v_mfma_f32_16x16x32_bf16 v[60:63], a[28:31], v[104:107], v[60:63]
  v_mfma_f32_16x16x32_bf16 v[64:67], a[16:19], v[108:111], v[64:67]
  v_mfma_f32_16x16x32_bf16 v[68:71], a[20:23], v[108:111], v[68:71]
  buffer_load_dwordx4 v[172:175], v11, s[28:31], s66 offen sc1
  s_add_u32 s67, s40, 1
  s_and_b32 s67, s67, 3
  s_mul_i32 s67, s67, 12288
  v_add_u32 v176, s67, v4
  v_mfma_f32_16x16x32_bf16 v[72:75], a[24:27], v[108:111], v[72:75]
  v_mfma_f32_16x16x32_bf16 v[76:79], a[28:31], v[108:111], v[76:79]
  v_mfma_f32_16x16x32_bf16 v[16:19], a[16:19], v[96:99], v[16:19]
  v_mfma_f32_16x16x32_bf16 v[20:23], a[20:23], v[96:99], v[20:23]
  buffer_load_dwordx4 v[160:163], v8, s[28:31], s66 offen sc1
  v_mfma_f32_16x16x32_bf16 v[24:27], a[24:27], v[96:99], v[24:27]
  v_mfma_f32_16x16x32_bf16 v[28:31], a[28:31], v[96:99], v[28:31]
  s_waitcnt vmcnt(12)
  v_mfma_f32_16x16x32_bf16 v[32:35], a[32:35], v[116:119], v[32:35]
  s_mul_i32 s65, s8, 131072
  s_add_u32 s8, s8, 1
  s_cmp_eq_u32 s8, s15
  s_cselect_b32 s8, 0, s8
  v_mfma_f32_16x16x32_bf16 v[36:39], a[36:39], v[116:119], v[36:39]
  buffer_load_dwordx4 v[84:87], v9, s[28:31], s65 offen sc1
  v_mfma_f32_16x16x32_bf16 v[40:43], a[40:43], v[116:119], v[40:43]
  v_mfma_f32_16x16x32_bf16 v[44:47], a[44:47], v[116:119], v[44:47]
  s_add_u32 s67, s40, 2
  s_and_b32 s67, s67, 3
  s_mul_i32 s67, s67, 12288
  v_add_u32 v177, s67, v4
  v_mfma_f32_16x16x32_bf16 v[48:51], a[32:35], v[120:123], v[48:51]
  v_mfma_f32_16x16x32_bf16 v[52:55], a[36:39], v[120:123], v[52:55]
  buffer_load_dwordx4 v[88:91], v10, s[28:31], s65 offen sc1
  v_mfma_f32_16x16x32_bf16 v[56:59], a[40:43], v[120:123], v[56:59]
  v_mfma_f32_16x16x32_bf16 v[60:63], a[44:47], v[120:123], v[60:63]
  v_mfma_f32_16x16x32_bf16 v[64:67], a[32:35], v[124:127], v[64:67]
  v_mfma_f32_16x16x32_bf16 v[68:71], a[36:39], v[124:127], v[68:71]
  buffer_load_dwordx4 v[92:95], v11, s[28:31], s65 offen sc1
  s_add_u32 s67, s40, 3
  s_and_b32 s67, s67, 3
  s_mul_i32 s67, s67, 12288
  v_add_u32 v178, s67, v4
  v_mfma_f32_16x16x32_bf16 v[72:75], a[40:43], v[124:127], v[72:75]
  v_mfma_f32_16x16x32_bf16 v[76:79], a[44:47], v[124:127], v[76:79]
  v_mfma_f32_16x16x32_bf16 v[16:19], a[32:35], v[112:115], v[16:19]
  v_mfma_f32_16x16x32_bf16 v[20:23], a[36:39], v[112:115], v[20:23]
  buffer_load_dwordx4 v[80:83], v8, s[28:31], s65 offen sc1
  v_mfma_f32_16x16x32_bf16 v[24:27], a[40:43], v[112:115], v[24:27]
  v_mfma_f32_16x16x32_bf16 v[28:31], a[44:47], v[112:115], v[28:31]
  s_waitcnt vmcnt(12)
  v_mfma_f32_16x16x32_bf16 v[32:35], a[48:51], v[132:135], v[32:35]
  s_mul_i32 s66, s8, 131072
  s_add_u32 s8, s8, 1
  s_cmp_eq_u32 s8, s15
  s_cselect_b32 s8, 0, s8
  v_mfma_f32_16x16x32_bf16 v[36:39], a[52:55], v[132:135], v[36:39]
  buffer_load_dwordx4 v[100:103], v9, s[28:31], s66 offen sc1
  v_mfma_f32_16x16x32_bf16 v[40:43], a[56:59], v[132:135], v[40:43]
  v_mfma_f32_16x16x32_bf16 v[44:47], a[60:63], v[132:135], v[44:47]
  s_mul_i32 s67, s40, 12288
  v_add_u32 v179, s67, v4
  v_mfma_f32_16x16x32_bf16 v[48:51], a[48:51], v[136:139], v[48:51]
  v_mfma_f32_16x16x32_bf16 v[52:55], a[52:55], v[136:139], v[52:55]
  buffer_load_dwordx4 v[104:107], v10, s[28:31], s66 offen sc1
  v_mfma_f32_16x16x32_bf16 v[56:59], a[56:59], v[136:139], v[56:59]
  v_mfma_f32_16x16x32_bf16 v[60:63], a[60:63], v[136:139], v[60:63]
  v_mfma_f32_16x16x32_bf16 v[64:67], a[48:51], v[140:143], v[64:67]
  v_mfma_f32_16x16x32_bf16 v[68:71], a[52:55], v[140:143], v[68:71]
  buffer_load_dwordx4 v[108:111], v11, s[28:31], s66 offen sc1
  v_sub_f32 v13, 1.0, v12
  v_mfma_f32_16x16x32_bf16 v[72:75], a[56:59], v[140:143], v[72:75]
  v_mfma_f32_16x16x32_bf16 v[76:79], a[60:63], v[140:143], v[76:79]
  v_mfma_f32_16x16x32_bf16 v[16:19], a[48:51], v[128:131], v[16:19]
  v_mfma_f32_16x16x32_bf16 v[20:23], a[52:55], v[128:131], v[20:23]
  buffer_load_dwordx4 v[96:99], v8, s[28:31], s66 offen sc1
  v_mfma_f32_16x16x32_bf16 v[24:27], a[56:59], v[128:131], v[24:27]
  v_mfma_f32_16x16x32_bf16 v[28:31], a[60:63], v[128:131], v[28:31]
  s_waitcnt vmcnt(12)
  v_mfma_f32_16x16x32_bf16 v[32:35], a[64:67], v[148:151], v[32:35]
  s_mul_i32 s65, s8, 131072
  s_add_u32 s8, s8, 1
  s_cmp_eq_u32 s8, s15
  s_cselect_b32 s8, 0, s8
  v_mfma_f32_16x16x32_bf16 v[36:39], a[68:71], v[148:151], v[36:39]
  buffer_load_dwordx4 v[116:119], v9, s[28:31], s65 offen sc1
  v_mfma_f32_16x16x32_bf16 v[40:43], a[72:75], v[148:151], v[40:43]
  v_mfma_f32_16x16x32_bf16 v[44:47], a[76:79], v[148:151], v[44:47]
  s_sub_u32 s67, s40, 0
  s_and_b32 s67, s67, 3
  s_cmp_eq_u32 s67, 0
  s_cselect_b64 s[68:69], -1, 0
  v_cndmask_b32 v180, v13, v12, s[68:69]
  v_mfma_f32_16x16x32_bf16 v[48:51], a[64:67], v[152:155], v[48:51]
  v_mfma_f32_16x16x32_bf16 v[52:55], a[68:71], v[152:155], v[52:55]
  buffer_load_dwordx4 v[120:123], v10, s[28:31], s65 offen sc1
  v_mfma_f32_16x16x32_bf16 v[56:59], a[72:75], v[152:155], v[56:59]
  v_mfma_f32_16x16x32_bf16 v[60:63], a[76:79], v[152:155], v[60:63]
  v_mfma_f32_16x16x32_bf16 v[64:67], a[64:67], v[156:159], v[64:67]
  v_mfma_f32_16x16x32_bf16 v[68:71], a[68:71], v[156:159], v[68:71]
  buffer_load_dwordx4 v[124:127], v11, s[28:31], s65 offen sc1
  s_sub_u32 s67, s40, 1
  s_and_b32 s67, s67, 3
  s_cmp_eq_u32 s67, 0
  s_cselect_b64 s[68:69], -1, 0
  v_cndmask_b32 v181, v13, v12, s[68:69]
  v_mfma_f32_16x16x32_bf16 v[72:75], a[72:75], v[156:159], v[72:75]
  v_mfma_f32_16x16x32_bf16 v[76:79], a[76:79], v[156:159], v[76:79]
  v_mfma_f32_16x16x32_bf16 v[16:19], a[64:67], v[144:147], v[16:19]
  v_mfma_f32_16x16x32_bf16 v[20:23], a[68:71], v[144:147], v[20:23]
  buffer_load_dwordx4 v[112:115], v8, s[28:31], s65 offen sc1
  v_mfma_f32_16x16x32_bf16 v[24:27], a[72:75], v[144:147], v[24:27]
  v_mfma_f32_16x16x32_bf16 v[28:31], a[76:79], v[144:147], v[28:31]
  s_waitcnt vmcnt(12)
  v_mfma_f32_16x16x32_bf16 v[32:35], a[80:83], v[164:167], v[32:35]
  s_mul_i32 s66, s8, 131072
  s_add_u32 s8, s8, 1
  s_cmp_eq_u32 s8, s15
  s_cselect_b32 s8, 0, s8
  v_mfma_f32_16x16x32_bf16 v[36:39], a[84:87], v[164:167], v[36:39]
  buffer_load_dwordx4 v[132:135], v9, s[28:31], s66 offen sc1
  v_mfma_f32_16x16x32_bf16 v[40:43], a[88:91], v[164:167], v[40:43]
  v_mfma_f32_16x16x32_bf16 v[44:47], a[92:95], v[164:167], v[44:47]
  s_sub_u32 s67, s40, 2
  s_and_b32 s67, s67, 3
  s_cmp_eq_u32 s67, 0
  s_cselect_b64 s[68:69], -1, 0
  v_cndmask_b32 v182, v13, v12, s[68:69]
  v_mfma_f32_16x16x32_bf16 v[48:51], a[80:83], v[168:171], v[48:51]
  v_mfma_f32_16x16x32_bf16 v[52:55], a[84:87], v[168:171], v[52:55]
  buffer_load_dwordx4 v[136:139], v10, s[28:31], s66 offen sc1
  v_mfma_f32_16x16x32_bf16 v[56:59], a[88:91], v[168:171], v[56:59]
  v_mfma_f32_16x16x32_bf16 v[60:63], a[92:95], v[168:171], v[60:63]
  v_mfma_f32_16x16x32_bf16 v[64:67], a[80:83], v[172:175], v[64:67]
  v_mfma_f32_16x16x32_bf16 v[68:71], a[84:87], v[172:175], v[68:71]
  buffer_load_dwordx4 v[140:143], v11, s[28:31], s66 offen sc1
  s_sub_u32 s67, s40, 3
  s_and_b32 s67, s67, 3
  s_cmp_eq_u32 s67, 0
  s_cselect_b64 s[68:69], -1, 0
  v_cndmask_b32 v183, v13, v12, s[68:69]
  v_mfma_f32_16x16x32_bf16 v[72:75], a[88:91], v[172:175], v[72:75]
  v_mfma_f32_16x16x32_bf16 v[76:79], a[92:95], v[172:175], v[76:79]
  v_mfma_f32_16x16x32_bf16 v[16:19], a[80:83], v[160:163], v[16:19]
  v_mfma_f32_16x16x32_bf16 v[20:23], a[84:87], v[160:163], v[20:23]
  buffer_load_dwordx4 v[128:131], v8, s[28:31], s66 offen sc1
  v_mfma_f32_16x16x32_bf16 v[24:27], a[88:91], v[160:163], v[24:27]
  v_mfma_f32_16x16x32_bf16 v[28:31], a[92:95], v[160:163], v[28:31]
  s_waitcnt vmcnt(12)
  v_mfma_f32_16x16x32_bf16 v[32:35], a[96:99], v[84:87], v[32:35]
  s_mul_i32 s65, s8, 131072
  s_add_u32 s8, s8, 1
  s_cmp_eq_u32 s8, s15
  s_cselect_b32 s8, 0, s8
  v_mfma_f32_16x16x32_bf16 v[36:39], a[100:103], v[84:87], v[36:39]
  buffer_load_dwordx4 v[148:151], v9, s[28:31], s65 offen sc1
  v_mfma_f32_16x16x32_bf16 v[40:43], a[104:107], v[84:87], v[40:43]
  v_mfma_f32_16x16x32_bf16 v[44:47], a[108:111], v[84:87], v[44:47]
  v_mfma_f32_16x16x32_bf16 v[48:51], a[96:99], v[88:91], v[48:51]
  v_mfma_f32_16x16x32_bf16 v[52:55], a[100:103], v[88:91], v[52:55]
  buffer_load_dwordx4 v[152:155], v10, s[28:31], s65 offen sc1
  v_mfma_f32_16x16x32_bf16 v[56:59], a[104:107], v[88:91], v[56:59]
  v_mfma_f32_16x16x32_bf16 v[60:63], a[108:111], v[88:91], v[60:63]
  v_mfma_f32_16x16x32_bf16 v[64:67], a[96:99], v[92:95], v[64:67]
  v_mfma_f32_16x16x32_bf16 v[68:71], a[100:103], v[92:95], v[68:71]
  buffer_load_dwordx4 v[156:159], v11, s[28:31], s65 offen sc1
  v_mfma_f32_16x16x32_bf16 v[72:75], a[104:107], v[92:95], v[72:75]
  v_mfma_f32_16x16x32_bf16 v[76:79], a[108:111], v[92:95], v[76:79]
  v_mfma_f32_16x16x32_bf16 v[16:19], a[96:99], v[80:83], v[16:19]
  v_mfma_f32_16x16x32_bf16 v[20:23], a[100:103], v[80:83], v[20:23]
  buffer_load_dwordx4 v[144:147], v8, s[28:31], s65 offen sc1
  v_mfma_f32_16x16x32_bf16 v[24:27], a[104:107], v[80:83], v[24:27]
  v_mfma_f32_16x16x32_bf16 v[28:31], a[108:111], v[80:83], v[28:31]
  s_waitcnt vmcnt(12)
  v_mfma_f32_16x16x32_bf16 v[32:35], a[112:115], v[100:103], v[32:35]
  s_mul_i32 s66, s8, 131072
  s_add_u32 s8, s8, 1
  s_cmp_eq_u32 s8, s15
  s_cselect_b32 s8, 0, s8
  v_mfma_f32_16x16x32_bf16 v[36:39], a[116:119], v[100:103], v[36:39]
  buffer_load_dwordx4 v[164:167], v9, s[28:31], s66 offen sc1
  v_mfma_f32_16x16x32_bf16 v[40:43], a[120:123], v[100:103], v[40:43]
  v_mfma_f32_16x16x32_bf16 v[44:47], a[124:127], v[100:103], v[44:47]
  v_mfma_f32_16x16x32_bf16 v[48:51], a[112:115], v[104:107], v[48:51]
  v_mfma_f32_16x16x32_bf16 v[52:55], a[116:119], v[104:107], v[52:55]
  buffer_load_dwordx4 v[168:171], v10, s[28:31], s66 offen sc1
  v_mfma_f32_16x16x32_bf16 v[56:59], a[120:123], v[104:107], v[56:59]
  v_mfma_f32_16x16x32_bf16 v[60:63], a[124:127], v[104:107], v[60:63]
  v_mfma_f32_16x16x32_bf16 v[64:67], a[112:115], v[108:111], v[64:67]
  v_mfma_f32_16x16x32_bf16 v[68:71], a[116:119], v[108:111], v[68:71]
  buffer_load_dwordx4 v[172:175], v11, s[28:31], s66 offen sc1
  v_mfma_f32_16x16x32_bf16 v[72:75], a[120:123], v[108:111], v[72:75]
  v_mfma_f32_16x16x32_bf16 v[76:79], a[124:127], v[108:111], v[76:79]
  v_mfma_f32_16x16x32_bf16 v[16:19], a[112:115], v[96:99], v[16:19]
  v_mfma_f32_16x16x32_bf16 v[20:23], a[116:119], v[96:99], v[20:23]
  buffer_load_dwordx4 v[160:163], v8, s[28:31], s66 offen sc1
  v_mfma_f32_16x16x32_bf16 v[24:27], a[120:123], v[96:99], v[24:27]
  v_mfma_f32_16x16x32_bf16 v[28:31], a[124:127], v[96:99], v[28:31]
  s_waitcnt vmcnt(12)
  v_mfma_f32_16x16x32_bf16 v[32:35], a[128:131], v[116:119], v[32:35]
  s_mul_i32 s65, s8, 131072
  s_add_u32 s8, s8, 1
  s_cmp_eq_u32 s8, s15
  s_cselect_b32 s8, 0, s8
  v_mfma_f32_16x16x32_bf16 v[36:39], a[132:135], v[116:119], v[36:39]
  buffer_load_dwordx4 v[84:87], v9, s[28:31], s65 offen sc1
  v_mfma_f32_16x16x32_bf16 v[40:43], a[136:139], v[116:119], v[40:43]
  v_mfma_f32_16x16x32_bf16 v[44:47], a[140:143], v[116:119], v[44:47]
  v_mfma_f32_16x16x32_bf16 v[48:51], a[128:131], v[120:123], v[48:51]
  v_mfma_f32_16x16x32_bf16 v[52:55], a[132:135], v[120:123], v[52:55]
  buffer_load_dwordx4 v[88:91], v10, s[28:31], s65 offen sc1
  v_mfma_f32_16x16x32_bf16 v[56:59], a[136:139], v[120:123], v[56:59]
  v_mfma_f32_16x16x32_bf16 v[60:63], a[140:143], v[120:123], v[60:63]
  v_mfma_f32_16x16x32_bf16 v[64:67], a[128:131], v[124:127], v[64:67]
  v_mfma_f32_16x16x32_bf16 v[68:71], a[132:135], v[124:127], v[68:71]
  buffer_load_dwordx4 v[92:95], v11, s[28:31], s65 offen sc1
  v_mfma_f32_16x16x32_bf16 v[72:75], a[136:139], v[124:127], v[72:75]
  v_mfma_f32_16x16x32_bf16 v[76:79], a[140:143], v[124:127], v[76:79]
  v_mfma_f32_16x16x32_bf16 v[16:19], a[128:131], v[112:115], v[16:19]
  v_mfma_f32_16x16x32_bf16 v[20:23], a[132:135], v[112:115], v[20:23]
  buffer_load_dwordx4 v[80:83], v8, s[28:31], s65 offen sc1
  v_mfma_f32_16x16x32_bf16 v[24:27], a[136:139], v[112:115], v[24:27]
  v_mfma_f32_16x16x32_bf16 v[28:31], a[140:143], v[112:115], v[28:31]
  s_waitcnt vmcnt(12)
  v_mfma_f32_16x16x32_bf16 v[32:35], a[144:147], v[132:135], v[32:35]
  s_mul_i32 s66, s8, 131072
  s_add_u32 s8, s8, 1
  s_cmp_eq_u32 s8, s15
  s_cselect_b32 s8, 0, s8
  v_mfma_f32_16x16x32_bf16 v[36:39], a[148:151], v[132:135], v[36:39]
  buffer_load_dwordx4 v[100:103], v9, s[28:31], s66 offen sc1
  v_mfma_f32_16x16x32_bf16 v[40:43], a[152:155], v[132:135], v[40:43]
  v_mfma_f32_16x16x32_bf16 v[44:47], a[156:159], v[132:135], v[44:47]
  v_mfma_f32_16x16x32_bf16 v[48:51], a[144:147], v[136:139], v[48:51]
  v_mfma_f32_16x16x32_bf16 v[52:55], a[148:151], v[136:139], v[52:55]
  buffer_load_dwordx4 v[104:107], v10, s[28:31], s66 offen sc1
  v_mfma_f32_16x16x32_bf16 v[56:59], a[152:155], v[136:139], v[56:59]
  v_mfma_f32_16x16x32_bf16 v[60:63], a[156:159], v[136:139], v[60:63]
  v_mfma_f32_16x16x32_bf16 v[64:67], a[144:147], v[140:143], v[64:67]
  v_mfma_f32_16x16x32_bf16 v[68:71], a[148:151], v[140:143], v[68:71]
  buffer_load_dwordx4 v[108:111], v11, s[28:31], s66 offen sc1
  v_mfma_f32_16x16x32_bf16 v[72:75], a[152:155], v[140:143], v[72:75]
  v_mfma_f32_16x16x32_bf16 v[76:79], a[156:159], v[140:143], v[76:79]
  v_mfma_f32_16x16x32_bf16 v[16:19], a[144:147], v[128:131], v[16:19]
  v_mfma_f32_16x16x32_bf16 v[20:23], a[148:151], v[128:131], v[20:23]
  buffer_load_dwordx4 v[96:99], v8, s[28:31], s66 offen sc1
  v_mfma_f32_16x16x32_bf16 v[24:27], a[152:155], v[128:131], v[24:27]
  v_mfma_f32_16x16x32_bf16 v[28:31], a[156:159], v[128:131], v[28:31]
  s_waitcnt vmcnt(12)
  v_mfma_f32_16x16x32_bf16 v[32:35], a[160:163], v[148:151], v[32:35]
  s_cmp_gt_u32 s15, 14
  s_cselect_b32 s65, s8, 31
  s_mul_i32 s65, s65, 131072
  s_add_u32 s8, s8, 1
  s_cmp_eq_u32 s8, s15
  s_cselect_b32 s8, 0, s8
  v_mfma_f32_16x16x32_bf16 v[36:39], a[164:167], v[148:151], v[36:39]
  buffer_load_dwordx4 v[116:119], v9, s[28:31], s65 offen sc1
  v_mfma_f32_16x16x32_bf16 v[40:43], a[168:171], v[148:151], v[40:43]
  v_mfma_f32_16x16x32_bf16 v[44:47], a[172:175], v[148:151], v[44:47]
  v_mfma_f32_16x16x32_bf16 v[48:51], a[160:163], v[152:155], v[48:51]
  v_mfma_f32_16x16x32_bf16 v[52:55], a[164:167], v[152:155], v[52:55]
  buffer_load_dwordx4 v[120:123], v10, s[28:31], s65 offen sc1
  v_mfma_f32_16x16x32_bf16 v[56:59], a[168:171], v[152:155], v[56:59]
  v_mfma_f32_16x16x32_bf16 v[60:63], a[172:175], v[152:155], v[60:63]
  v_mfma_f32_16x16x32_bf16 v[64:67], a[160:163], v[156:159], v[64:67]
  v_mfma_f32_16x16x32_bf16 v[68:71], a[164:167], v[156:159], v[68:71]
  buffer_load_dwordx4 v[124:127], v11, s[28:31], s65 offen sc1
  v_mfma_f32_16x16x32_bf16 v[72:75], a[168:171], v[156:159], v[72:75]
  v_mfma_f32_16x16x32_bf16 v[76:79], a[172:175], v[156:159], v[76:79]
  v_mfma_f32_16x16x32_bf16 v[16:19], a[160:163], v[144:147], v[16:19]
  v_mfma_f32_16x16x32_bf16 v[20:23], a[164:167], v[144:147], v[20:23]
  buffer_load_dwordx4 v[112:115], v8, s[28:31], s65 offen sc1
  v_mfma_f32_16x16x32_bf16 v[24:27], a[168:171], v[144:147], v[24:27]
  v_mfma_f32_16x16x32_bf16 v[28:31], a[172:175], v[144:147], v[28:31]
  s_waitcnt vmcnt(12)
  v_mfma_f32_16x16x32_bf16 v[32:35], a[176:179], v[164:167], v[32:35]
  s_cmp_gt_u32 s15, 15
  s_cselect_b32 s66, s8, 31
  s_mul_i32 s66, s66, 131072
  s_add_u32 s8, s8, 1
  s_cmp_eq_u32 s8, s15
  s_cselect_b32 s8, 0, s8
  v_mfma_f32_16x16x32_bf16 v[36:39], a[180:183], v[164:167], v[36:39]
  buffer_load_dwordx4 v[132:135], v9, s[28:31], s66 offen sc1
  v_mfma_f32_16x16x32_bf16 v[40:43], a[184:187], v[164:167], v[40:43]
  v_mfma_f32_16x16x32_bf16 v[44:47], a[188:191], v[164:167], v[44:47]
  v_mfma_f32_16x16x32_bf16 v[48:51], a[176:179], v[168:171], v[48:51]
  v_mfma_f32_16x16x32_bf16 v[52:55], a[180:183], v[168:171], v[52:55]
  buffer_load_dwordx4 v[136:139], v10, s[28:31], s66 offen sc1
  v_mfma_f32_16x16x32_bf16 v[56:59], a[184:187], v[168:171], v[56:59]
  v_mfma_f32_16x16x32_bf16 v[60:63], a[188:191], v[168:171], v[60:63]
  v_mfma_f32_16x16x32_bf16 v[64:67], a[176:179], v[172:175], v[64:67]
  v_mfma_f32_16x16x32_bf16 v[68:71], a[180:183], v[172:175], v[68:71]
  buffer_load_dwordx4 v[140:143], v11, s[28:31], s66 offen sc1
  v_mfma_f32_16x16x32_bf16 v[72:75], a[184:187], v[172:175], v[72:75]
  v_mfma_f32_16x16x32_bf16 v[76:79], a[188:191], v[172:175], v[76:79]
  v_mfma_f32_16x16x32_bf16 v[16:19], a[176:179], v[160:163], v[16:19]
  v_mfma_f32_16x16x32_bf16 v[20:23], a[180:183], v[160:163], v[20:23]
  buffer_load_dwordx4 v[128:131], v8, s[28:31], s66 offen sc1
  v_mfma_f32_16x16x32_bf16 v[24:27], a[184:187], v[160:163], v[24:27]
  v_mfma_f32_16x16x32_bf16 v[28:31], a[188:191], v[160:163], v[28:31]
  s_waitcnt vmcnt(12)
  v_mfma_f32_16x16x32_bf16 v[32:35], a[192:195], v[84:87], v[32:35]
  v_mfma_f32_16x16x32_bf16 v[36:39], a[196:199], v[84:87], v[36:39]
  v_mfma_f32_16x16x32_bf16 v[40:43], a[200:203], v[84:87], v[40:43]
  v_mfma_f32_16x16x32_bf16 v[44:47], a[204:207], v[84:87], v[44:47]
  v_mfma_f32_16x16x32_bf16 v[48:51], a[192:195], v[88:91], v[48:51]
  v_mfma_f32_16x16x32_bf16 v[52:55], a[196:199], v[88:91], v[52:55]
  v_mfma_f32_16x16x32_bf16 v[56:59], a[200:203], v[88:91], v[56:59]
  v_mfma_f32_16x16x32_bf16 v[60:63], a[204:207], v[88:91], v[60:63]
  v_mfma_f32_16x16x32_bf16 v[64:67], a[192:195], v[92:95], v[64:67]
  v_mfma_f32_16x16x32_bf16 v[68:71], a[196:199], v[92:95], v[68:71]
  v_mfma_f32_16x16x32_bf16 v[72:75], a[200:203], v[92:95], v[72:75]
  v_mfma_f32_16x16x32_bf16 v[76:79], a[204:207], v[92:95], v[76:79]
  v_mfma_f32_16x16x32_bf16 v[16:19], a[192:195], v[80:83], v[16:19]
  v_mfma_f32_16x16x32_bf16 v[20:23], a[196:199], v[80:83], v[20:23]
  v_mfma_f32_16x16x32_bf16 v[24:27], a[200:203], v[80:83], v[24:27]
  v_mfma_f32_16x16x32_bf16 v[28:31], a[204:207], v[80:83], v[28:31]
  s_waitcnt vmcnt(8)
  v_mfma_f32_16x16x32_bf16 v[32:35], a[208:211], v[100:103], v[32:35]
  v_mfma_f32_16x16x32_bf16 v[36:39], a[212:215], v[100:103], v[36:39]
  v_mfma_f32_16x16x32_bf16 v[40:43], a[216:219], v[100:103], v[40:43]
  v_mfma_f32_16x16x32_bf16 v[44:47], a[220:223], v[100:103], v[44:47]
  v_mfma_f32_16x16x32_bf16 v[48:51], a[208:211], v[104:107], v[48:51]
  v_mfma_f32_16x16x32_bf16 v[52:55], a[212:215], v[104:107], v[52:55]
  v_mfma_f32_16x16x32_bf16 v[56:59], a[216:219], v[104:107], v[56:59]
  v_mfma_f32_16x16x32_bf16 v[60:63], a[220:223], v[104:107], v[60:63]
  v_mfma_f32_16x16x32_bf16 v[64:67], a[208:211], v[108:111], v[64:67]
  v_mfma_f32_16x16x32_bf16 v[68:71], a[212:215], v[108:111], v[68:71]
  v_mfma_f32_16x16x32_bf16 v[72:75], a[216:219], v[108:111], v[72:75]
  v_mfma_f32_16x16x32_bf16 v[76:79], a[220:223], v[108:111], v[76:79]
  v_mfma_f32_16x16x32_bf16 v[16:19], a[208:211], v[96:99], v[16:19]
  v_mfma_f32_16x16x32_bf16 v[20:23], a[212:215], v[96:99], v[20:23]
  v_mfma_f32_16x16x32_bf16 v[24:27], a[216:219], v[96:99], v[24:27]
  v_mfma_f32_16x16x32_bf16 v[28:31], a[220:223], v[96:99], v[28:31]
  s_cmp_gt_u32 s15, 14
  s_cbranch_scc0 Lp2_short
  s_waitcnt vmcnt(4)
  v_mfma_f32_16x16x32_bf16 v[32:35], a[224:227], v[116:119], v[32:35]
  v_mfma_f32_16x16x32_bf16 v[36:39], a[228:231], v[116:119], v[36:39]
  v_mfma_f32_16x16x32_bf16 v[40:43], a[232:235], v[116:119], v[40:43]
  v_mfma_f32_16x16x32_bf16 v[44:47], a[236:239], v[116:119], v[44:47]
  v_mfma_f32_16x16x32_bf16 v[48:51], a[224:227], v[120:123], v[48:51]
  v_mfma_f32_16x16x32_bf16 v[52:55], a[228:231], v[120:123], v[52:55]
  v_mfma_f32_16x16x32_bf16 v[56:59], a[232:235], v[120:123], v[56:59]
  v_mfma_f32_16x16x32_bf16 v[60:63], a[236:239], v[120:123], v[60:63]
  v_mfma_f32_16x16x32_bf16 v[64:67], a[224:227], v[124:127], v[64:67]
  v_mfma_f32_16x16x32_bf16 v[68:71], a[228:231], v[124:127], v[68:71]
  v_mfma_f32_16x16x32_bf16 v[72:75], a[232:235], v[124:127], v[72:75]
  v_mfma_f32_16x16x32_bf16 v[76:79], a[236:239], v[124:127], v[76:79]
  v_mfma_f32_16x16x32_bf16 v[16:19], a[224:227], v[112:115], v[16:19]
  v_mfma_f32_16x16x32_bf16 v[20:23], a[228:231], v[112:115], v[20:23]
  v_mfma_f32_16x16x32_bf16 v[24:27], a[232:235], v[112:115], v[24:27]
  v_mfma_f32_16x16x32_bf16 v[28:31], a[236:239], v[112:115], v[28:31]
  s_cmp_gt_u32 s15, 15
  s_cbranch_scc0 Lp2_short
  s_waitcnt vmcnt(0)
  v_mfma_f32_16x16x32_bf16 v[32:35], a[240:243], v[132:135], v[32:35]
  v_mfma_f32_16x16x32_bf16 v[36:39], a[244:247], v[132:135], v[36:39]
  v_mfma_f32_16x16x32_bf16 v[40:43], a[248:251], v[132:135], v[40:43]
  v_mfma_f32_16x16x32_bf16 v[44:47], a[252:255], v[132:135], v[44:47]
  v_mfma_f32_16x16x32_bf16 v[48:51], a[240:243], v[136:139], v[48:51]
  v_mfma_f32_16x16x32_bf16 v[52:55], a[244:247], v[136:139], v[52:55]
  v_mfma_f32_16x16x32_bf16 v[56:59], a[248:251], v[136:139], v[56:59]
  v_mfma_f32_16x16x32_bf16 v[60:63], a[252:255], v[136:139], v[60:63]
  v_mfma_f32_16x16x32_bf16 v[64:67], a[240:243], v[140:143], v[64:67]
  ds_write_b128 v176, v[32:35] offset:0
  v_mfma_f32_16x16x32_bf16 v[68:71], a[244:247], v[140:143], v[68:71]
  ds_write_b128 v176, v[36:39] offset:1024
  v_mfma_f32_16x16x32_bf16 v[72:75], a[248:251], v[140:143], v[72:75]
  ds_write_b128 v176, v[40:43] offset:2048
  v_mfma_f32_16x16x32_bf16 v[76:79], a[252:255], v[140:143], v[76:79]
  ds_write_b128 v176, v[44:47] offset:3072
  v_mfma_f32_16x16x32_bf16 v[16:19], a[240:243], v[128:131], v[16:19]
  ds_write_b128 v177, v[48:51] offset:4096
  v_mfma_f32_16x16x32_bf16 v[20:23], a[244:247], v[128:131], v[20:23]
  ds_write_b128 v177, v[52:55] offset:5120
  v_mfma_f32_16x16x32_bf16 v[24:27], a[248:251], v[128:131], v[24:27]
  ds_write_b128 v177, v[56:59] offset:6144
  v_mfma_f32_16x16x32_bf16 v[28:31], a[252:255], v[128:131], v[28:31]
  ds_write_b128 v177, v[60:63] offset:7168
  s_nop 1
  s_branch Lp2_red
Lp2_short:
  s_waitcnt vmcnt(0)
  s_nop 7
  ds_write_b128 v176, v[32:35] offset:0
  ds_write_b128 v176, v[36:39] offset:1024
  ds_write_b128 v176, v[40:43] offset:2048
  ds_write_b128 v176, v[44:47] offset:3072
  ds_write_b128 v177, v[48:51] offset:4096
  ds_write_b128 v177, v[52:55] offset:5120
  ds_write_b128 v177, v[56:59] offset:6144
  ds_write_b128 v177, v[60:63] offset:7168
Lp2_red:
  ds_write_b128 v178, v[64:67] offset:8192
  ds_write_b128 v178, v[68:71] offset:9216
  ds_write_b128 v178, v[72:75] offset:10240
  ds_write_b128 v178, v[76:79] offset:11264
  v_pk_mul_f32 v[16:17], v[16:17], v[180:181] op_sel_hi:[1,0]
  v_pk_mul_f32 v[18:19], v[18:19], v[180:181] op_sel_hi:[1,0]
  v_pk_mul_f32 v[20:21], v[20:21], v[180:181] op_sel_hi:[1,0]
  v_pk_mul_f32 v[22:23], v[22:23], v[180:181] op_sel_hi:[1,0]
  v_pk_mul_f32 v[24:25], v[24:25], v[180:181] op_sel_hi:[1,0]
  v_pk_mul_f32 v[26:27], v[26:27], v[180:181] op_sel_hi:[1,0]
  v_pk_mul_f32 v[28:29], v[28:29], v[180:181] op_sel_hi:[1,0]
  v_pk_mul_f32 v[30:31], v[30:31], v[180:181] op_sel_hi:[1,0]
  s_waitcnt lgkmcnt(0)
  s_barrier
  ds_read_b128 v[80:83], v179 offset:0
  ds_read_b128 v[84:87], v179 offset:1024
  ds_read_b128 v[88:91], v179 offset:2048
  ds_read_b128 v[92:95], v179 offset:3072
  ds_read_b128 v[96:99], v179 offset:4096
  ds_read_b128 v[100:103], v179 offset:5120
  ds_read_b128 v[104:107], v179 offset:6144
  ds_read_b128 v[108:111], v179 offset:7168
  ds_read_b128 v[112:115], v179 offset:8192
  ds_read_b128 v[116:119], v179 offset:9216
  ds_read_b128 v[120:123], v179 offset:10240
  ds_read_b128 v[124:127], v179 offset:11264
  s_waitcnt lgkmcnt(8)
  v_pk_fma_f32 v[16:17], v[80:81], v[180:181], v[16:17] op_sel:[0,1,0] op_sel_hi:[1,1,1]
  v_pk_fma_f32 v[18:19], v[82:83], v[180:181], v[18:19] op_sel:[0,1,0] op_sel_hi:[1,1,1]
  v_pk_fma_f32 v[20:21], v[84:85], v[180:181], v[20:21] op_sel:[0,1,0] op_sel_hi:[1,1,1]
  v_pk_fma_f32 v[22:23], v[86:87], v[180:181], v[22:23] op_sel:[0,1,0] op_sel_hi:[1,1,1]
  v_pk_fma_f32 v[24:25], v[88:89], v[180:181], v[24:25] op_sel:[0,1,0] op_sel_hi:[1,1,1]
  v_pk_fma_f32 v[26:27], v[90:91], v[180:181], v[26:27] op_sel:[0,1,0] op_sel_hi:[1,1,1]
  v_pk_fma_f32 v[28:29], v[92:93], v[180:181], v[28:29] op_sel:[0,1,0] op_sel_hi:[1,1,1]
  v_pk_fma_f32 v[30:31], v[94:95], v[180:181], v[30:31] op_sel:[0,1,0] op_sel_hi:[1,1,1]
  s_waitcnt lgkmcnt(4)
  v_pk_fma_f32 v[16:17], v[96:97], v[182:183], v[16:17] op_sel:[0,0,0] op_sel_hi:[1,0,1]
  v_pk_fma_f32 v[18:19], v[98:99], v[182:183], v[18:19] op_sel:[0,0,0] op_sel_hi:[1,0,1]
  v_pk_fma_f32 v[20:21], v[100:101], v[182:183], v[20:21] op_sel:[0,0,0] op_sel_hi:[1,0,1]
  v_pk_fma_f32 v[22:23], v[102:103], v[182:183], v[22:23] op_sel:[0,0,0] op_sel_hi:[1,0,1]
  v_pk_fma_f32 v[24:25], v[104:105], v[182:183], v[24:25] op_sel:[0,0,0] op_sel_hi:[1,0,1]
  v_pk_fma_f32 v[26:27], v[106:107], v[182:183], v[26:27] op_sel:[0,0,0] op_sel_hi:[1,0,1]
  v_pk_fma_f32 v[28:29], v[108:109], v[182:183], v[28:29] op_sel:[0,0,0] op_sel_hi:[1,0,1]
  v_pk_fma_f32 v[30:31], v[110:111], v[182:183], v[30:31] op_sel:[0,0,0] op_sel_hi:[1,0,1]
  s_waitcnt lgkmcnt(0)
  v_pk_fma_f32 v[16:17], v[112:113], v[182:183], v[16:17] op_sel:[0,1,0] op_sel_hi:[1,1,1]
  v_pk_fma_f32 v[18:19], v[114:115], v[182:183], v[18:19] op_sel:[0,1,0] op_sel_hi:[1,1,1]
  v_pk_fma_f32 v[20:21], v[116:117], v[182:183], v[20:21] op_sel:[0,1,0] op_sel_hi:[1,1,1]
  v_pk_fma_f32 v[22:23], v[118:119], v[182:183], v[22:23] op_sel:[0,1,0] op_sel_hi:[1,1,1]
  v_pk_fma_f32 v[24:25], v[120:121], v[182:183], v[24:25] op_sel:[0,1,0] op_sel_hi:[1,1,1]
  v_pk_fma_f32 v[26:27], v[122:123], v[182:183], v[26:27] op_sel:[0,1,0] op_sel_hi:[1,1,1]
  v_pk_fma_f32 v[28:29], v[124:125], v[182:183], v[28:29] op_sel:[0,1,0] op_sel_hi:[1,1,1]
  v_pk_fma_f32 v[30:31], v[126:127], v[182:183], v[30:31] op_sel:[0,1,0] op_sel_hi:[1,1,1]
  v_cvt_pk_bf16_f32 v32, v16, v17
  v_cvt_pk_bf16_f32 v33, v18, v19
  v_cvt_pk_bf16_f32 v34, v20, v21
  v_cvt_pk_bf16_f32 v35, v22, v23
  v_cvt_pk_bf16_f32 v36, v24, v25
  v_cvt_pk_bf16_f32 v37, v26, v27
  v_cvt_pk_bf16_f32 v38, v28, v29
  v_cvt_pk_bf16_f32 v39, v30, v31
  s_nop 1
  v_permlane16_swap_b32 v32, v34
  v_permlane16_swap_b32 v33, v35
  v_permlane16_swap_b32 v36, v38
  v_permlane16_swap_b32 v37, v39
  buffer_store_dwordx4 v[32:35], v0, s[16:19], 0 offen offset:0
  buffer_store_dwordx4 v[36:39], v0, s[16:19], 0 offen offset:64
Lend:
  s_endpgm
.section .rodata,"a"
.p2align 6
.amdhsa_kernel gated_mix__sliding_local_dilated__dense_activation_mish__prompt_kernel
  .amdhsa_next_free_vgpr 512
  .amdhsa_next_free_sgpr 102
  .amdhsa_accum_offset 256
  .amdhsa_group_segment_fixed_size 0
  .amdhsa_kernarg_size 88
  .amdhsa_user_sgpr_count 2
  .amdhsa_user_sgpr_kernarg_segment_ptr 1
  .amdhsa_system_sgpr_workgroup_id_x 1
.end_amdhsa_kernel
```
